```python
import torch

def _softmax(x, axis=-1):
    return torch.softmax(x, dim=axis)
def _gelu(x):
    return torch.nn.functional.gelu(x, approximate="tanh")
def _silu(x):
    return torch.nn.functional.silu(x)
def _sigmoid(x):
    return torch.sigmoid(x)
def _layernorm(x, axis=-1, eps=1e-5):
    m = x.mean(dim=axis, keepdim=True)
    v = x.var(dim=axis, keepdim=True, unbiased=False)
    return (x - m) / torch.sqrt(v + eps)
def _scatter_add(tgt, idx, src, axis=0):
    return tgt.clone().index_add_(axis, idx, src)
def _segment_sum(src, seg, n):
    out = torch.zeros((n,) + src.shape[1:], dtype=src.dtype)
    return out.index_add_(0, seg, src)
def _pad(x, pw):
    flat = tuple(v for pair in reversed(pw) for v in pair)
    return torch.nn.functional.pad(x, flat)

kernel_name = 'sequential_preLN__sliding_local_dilated__dense_activation_relu__prompt'

def setup_inputs():

    _w = (lambda a: (lambda t: t.to(torch.bfloat16) if t.is_floating_point() else t)(torch.as_tensor(a)))
    def _A_setup():
        B, S, D = 1, 2048, 512
        return {
            "x": _w((lambda *s: torch.randn(*s, dtype=torch.bfloat16) * 0.05)(B, S, D)),
            "wqkv": _w((lambda *s: torch.randn(*s, dtype=torch.bfloat16) * 0.05)(D, 3 * D)),
            "wo": _w((lambda *s: torch.randn(*s, dtype=torch.bfloat16) * 0.05)(D, D)),
        }
    _A_in = _A_setup()

    def _B_setup():
        B, S, D, Dff = 1, 2048, 512, 1376
        return {
            "x": _w((lambda *s: torch.randn(*s, dtype=torch.bfloat16) * 0.05)(B, S, D)),
            "w1": _w((lambda *s: torch.randn(*s, dtype=torch.bfloat16) * 0.05)(D, Dff)),
            "w2": _w((lambda *s: torch.randn(*s, dtype=torch.bfloat16) * 0.05)(Dff, D)),
        }
    _B_in = _B_setup()

    return {
        "A_x": _A_in["x"],
        "A_wqkv": _A_in["wqkv"],
        "A_wo": _A_in["wo"],
        "B_x": _B_in["x"],
        "B_w1": _B_in["w1"],
        "B_w2": _B_in["w2"],
    }

def reference(A_x, A_wqkv, A_wo, B_x, B_w1, B_w2):
    def _A_ref(x, wqkv, wo):
        B, S, D = x.shape
        H = 32; Dh = D // H
        W, dil = 8, 2
        qkv = (lambda x, *d: x.permute(*d))((x @ wqkv).reshape(B, S, 3, H, Dh), 2, 0, 3, 1, 4)
        q, k, v = qkv[0], qkv[1], qkv[2]
        scale = Dh ** -0.5
        pos = torch.arange(S)
        off = torch.arange(W) * dil
        idx = pos[:, None] - off[None, :]
        mask = idx >= 0
        idx_c = torch.where(mask, idx, 0).reshape(-1)
        kg = k[:, :, idx_c, :].reshape(B, H, S, W, Dh)
        vg = v[:, :, idx_c, :].reshape(B, H, S, W, Dh)
        logits = torch.einsum("bhsd,bhswd->bhsw", q, kg) * scale
        logits = torch.where(mask[None, None, :, :], logits, -1e9)
        attn = _softmax(logits, axis=-1)
        o = torch.einsum("bhsw,bhswd->bhsd", attn, vg)
        return (lambda x, *d: x.permute(*d))(o, 0, 2, 1, 3).reshape(B, S, D) @ wo

    def _B_ref(x, w1, w2):
        h = torch.einsum("bsd,df->bsf", x, w1)
        zero = torch.zeros_like(h)
        h = torch.maximum(h, zero)
        return torch.einsum("bsf,fd->bsd", h, w2)

    x = A_x
    h = x + _A_ref(_layernorm(x, axis=-1), A_wqkv, A_wo)
    h2 = h + _B_ref(_layernorm(h, axis=-1), B_w1, B_w2)
    return h2
```

```asm
; @launch grid=(256,1,1) block=(512,1,1) lds=163840
.amdgcn_target "amdgcn-amd-amdhsa--gfx950"
.text
.globl sequential_preLN__sliding_local_dilated__dense_activation_relu__prompt_kernel
.p2align 8
.type sequential_preLN__sliding_local_dilated__dense_activation_relu__prompt_kernel,@function
sequential_preLN__sliding_local_dilated__dense_activation_relu__prompt_kernel:
  s_cmp_ge_u32 s2, 256
  s_cbranch_scc1 L_END
  s_load_dwordx16 s[40:55], s[0:1], 0
  s_load_dwordx2 s[56:57], s[0:1], 64
  v_lshrrev_b32 v6, 6, v0
  v_and_b32 v2, 63, v0
  v_readfirstlane_b32 s3, v6
  v_and_b32 v3, 15, v2
  v_lshrrev_b32 v4, 4, v2
  v_lshlrev_b32 v5, 4, v2
  s_getreg_b32 s5, hwreg(HW_REG_XCC_ID)
  s_and_b32 s5, s5, 7
  s_and_b32 s4, s3, 3
  s_waitcnt lgkmcnt(0)
  s_mov_b32 s8, s40
  s_and_b32 s9, s41, 0xffff
  s_mov_b32 s10, 2097152
  s_mov_b32 s11, 0x20000
  s_mov_b32 s12, s42
  s_and_b32 s13, s43, 0xffff
  s_mov_b32 s14, 1572864
  s_mov_b32 s15, 0x20000
  s_mov_b32 s16, s44
  s_and_b32 s17, s45, 0xffff
  s_mov_b32 s18, 524288
  s_mov_b32 s19, 0x20000
  s_mov_b32 s20, s48
  s_and_b32 s21, s49, 0xffff
  s_mov_b32 s22, 1409024
  s_mov_b32 s23, 0x20000
  s_mov_b32 s24, s50
  s_and_b32 s25, s51, 0xffff
  s_mov_b32 s26, 1409024
  s_mov_b32 s27, 0x20000
  s_mov_b32 s28, s52
  s_and_b32 s29, s53, 0xffff
  s_mov_b32 s30, 2097152
  s_mov_b32 s31, 0x20000
  s_mov_b32 s32, s54
  s_and_b32 s33, s55, 0xffff
  s_mov_b32 s34, 256
  s_mov_b32 s35, 0x20000
  s_mov_b32 s36, s56
  s_and_b32 s37, s57, 0xffff
  s_mov_b32 s38, 268435456
  s_mov_b32 s39, 0x20000
  s_lshr_b32 s6, s2, 3
  s_mov_b32 s7, 0
  s_cmp_ge_u32 s3, 4
  s_cbranch_scc1 L_PROD
  s_cmp_lg_u32 s3, 0
  s_cbranch_scc1 L_CONS
  s_mul_i32 s58, s5, 2048
  s_add_u32 s58, s58, 9961472
  s_lshl_b32 s59, s6, 4
  s_add_u32 s59, s59, s58
  v_mov_b32 v20, 0
  v_mov_b32 v21, 0
  v_mov_b32 v22, 0
  v_mov_b32 v23, 0
  v_lshlrev_b32 v7, 9, v2
  s_mov_b64 exec, 15
  buffer_store_dwordx4 v[20:23], v7, s[36:39], s59 offen
  s_mov_b64 exec, -1
  v_lshlrev_b32 v7, 2, v2
  buffer_load_dword v19, v7, s[32:35], 0 offen sc1
  v_lshlrev_b32 v7, 7, v2
  s_mov_b64 exec, 0xfff
  buffer_load_dword v17, v7, s[36:39], s58 offen sc1
  s_mov_b64 exec, -1
L_CONS:
  s_lshr_b32 s40, s6, 3
  s_lshl_b32 s41, s5, 2
  s_add_u32 s40, s40, s41
  s_and_b32 s41, s6, 7
  s_lshr_b32 s42, s40, 1
  s_and_b32 s43, s6, 15
  v_mov_b32 v24, 0x3f803f80
  v_mov_b32 v25, 0x3f803f80
  v_mov_b32 v26, 0x3f803f80
  v_mov_b32 v27, 0x3f803f80
  ds_write_b128 v5, v[24:27]
  s_lshl_b32 s58, s4, 11
  v_lshrrev_b32 v6, 1, v3
  v_xor_b32 v6, v4, v6
  v_lshlrev_b32 v6, 4, v6
  v_lshl_add_u32 v37, v3, 7, v6
  v_xor_b32 v38, 64, v37
  v_add_u32 v39, s58, v37
  v_add_u32 v40, s58, v38
  v_bfe_u32 v6, v2, 2, 2
  v_and_b32 v7, 3, v2
  v_lshrrev_b32 v8, 1, v6
  v_and_b32 v9, 1, v4
  v_lshl_add_u32 v8, v9, 1, v8
  v_xor_b32 v8, s4, v8
  v_lshlrev_b32 v8, 5, v8
  v_lshl_add_u32 v8, v7, 3, v8
  v_lshl_add_u32 v6, v4, 3, v6
  v_lshl_add_u32 v41, v6, 7, v8
  v_add_u32 v42, 65536, v37
  v_add_u32 v43, 131072, v37
  v_add_u32 v44, 65536, v38
  v_add_u32 v45, 131072, v38
  v_add_u32 v46, 65536, v39
  v_add_u32 v47, 131072, v39
  v_add_u32 v48, 65536, v40
  v_add_u32 v49, 131072, v40
  v_add_u32 v50, 65536, v41
  v_add_u32 v51, 131072, v41
  v_xor_b32 v6, v4, v3
  v_lshlrev_b32 v6, 4, v6
  v_lshl_add_u32 v52, v3, 10, v6
  v_xor_b32 v53, 64, v52
  v_xor_b32 v54, 128, v52
  v_xor_b32 v55, 192, v52
  v_mov_b32 v56, 0
  v_mov_b32 v57, 0
  v_mov_b32 v58, 0
  v_mov_b32 v59, 0
  v_mov_b32 v60, 0
  v_mov_b32 v61, 0
  v_mov_b32 v62, 0
  v_mov_b32 v63, 0
  v_mov_b32 v64, 0
  v_mov_b32 v65, 0
  v_mov_b32 v66, 0
  v_mov_b32 v67, 0
  v_mov_b32 v68, 0
  v_mov_b32 v69, 0
  v_mov_b32 v70, 0
  v_mov_b32 v71, 0
  v_mov_b32 v72, 0
  v_mov_b32 v73, 0
  v_mov_b32 v74, 0
  v_mov_b32 v75, 0
  v_mov_b32 v76, 0
  v_mov_b32 v77, 0
  v_mov_b32 v78, 0
  v_mov_b32 v79, 0
  v_mov_b32 v80, 0
  v_mov_b32 v81, 0
  v_mov_b32 v82, 0
  v_mov_b32 v83, 0
  v_mov_b32 v84, 0
  v_mov_b32 v85, 0
  v_mov_b32 v86, 0
  v_mov_b32 v87, 0
  v_mov_b32 v88, 0
  v_mov_b32 v89, 0
  v_mov_b32 v90, 0
  v_mov_b32 v91, 0
  v_mov_b32 v92, 0
  v_mov_b32 v93, 0
  v_mov_b32 v94, 0
  v_mov_b32 v95, 0
  v_mov_b32 v96, 0
  v_mov_b32 v97, 0
  v_mov_b32 v98, 0
  v_mov_b32 v99, 0
  v_mov_b32 v100, 0
  v_mov_b32 v101, 0
  v_mov_b32 v102, 0
  v_mov_b32 v103, 0
  v_mov_b32 v104, 0
  v_mov_b32 v105, 0
  v_mov_b32 v106, 0
  v_mov_b32 v107, 0
  v_mov_b32 v108, 0
  v_mov_b32 v109, 0
  v_mov_b32 v110, 0
  v_mov_b32 v111, 0
  v_mov_b32 v112, 0
  v_mov_b32 v113, 0
  v_mov_b32 v114, 0
  v_mov_b32 v115, 0
  v_mov_b32 v116, 0
  v_mov_b32 v117, 0
  v_mov_b32 v118, 0
  v_mov_b32 v119, 0
  v_mov_b32 v120, 0
  v_mov_b32 v121, 0
  v_mov_b32 v122, 0
  v_mov_b32 v123, 0
  v_mov_b32 v124, 0
  v_mov_b32 v125, 0
  v_mov_b32 v126, 0
  v_mov_b32 v127, 0
  v_mov_b32 v128, 0
  v_mov_b32 v129, 0
  v_mov_b32 v130, 0
  v_mov_b32 v131, 0
  v_lshlrev_b32 v6, 2, v4
  v_sub_u32 v132, v6, v3
  v_add_u32 v7, 7, v132
  v_cmp_gt_u32 s[60:61], 8, v7
  v_cmp_le_i32 s[68:69], 9, v132
  v_cmp_le_i32 s[76:77], 1, v132
  v_add_u32 v7, 8, v132
  v_cmp_gt_u32 s[62:63], 8, v7
  v_cmp_le_i32 s[70:71], 8, v132
  v_cmp_le_i32 s[78:79], 0, v132
  v_add_u32 v7, 9, v132
  v_cmp_gt_u32 s[64:65], 8, v7
  v_cmp_le_i32 s[72:73], 7, v132
  v_cmp_le_i32 s[80:81], -1, v132
  v_add_u32 v7, 10, v132
  v_cmp_gt_u32 s[66:67], 8, v7
  v_cmp_le_i32 s[74:75], 6, v132
  v_cmp_le_i32 s[82:83], -2, v132
  v_cmp_gt_u32 s[92:93], 2, v4
  v_and_b32 v6, 3, v3
  v_cmp_eq_u32 s[44:45], 1, v6
  v_cmp_eq_u32 s[46:47], 2, v6
  v_cmp_eq_u32 s[48:49], 3, v6
  v_lshrrev_b32 v6, 2, v3
  v_cmp_eq_u32 s[50:51], v4, v6
  s_or_b32 s58, s3, s7
  s_cmp_lg_u32 s58, 0
  s_cbranch_scc1 L_NOBYTE
  s_waitcnt vmcnt(0)
  s_or_b32 s58, s5, 16
  v_mov_b32 v6, s58
  v_mov_b32 v7, 0
  s_mov_b64 exec, 1
  buffer_store_byte v6, v7, s[32:35], s2 offen
  s_mov_b64 exec, -1
L_NOBYTE:
  s_waitcnt lgkmcnt(0)
  s_cmp_eq_u32 s40, 0
  s_cselect_b32 s94, 0, -1
  s_mov_b32 s95, s94
  s_and_b64 s[92:93], s[92:93], s[94:95]
  s_and_b64 s[76:77], s[76:77], s[92:93]
  s_and_b64 s[84:85], s[68:69], s[94:95]
  s_and_b64 s[78:79], s[78:79], s[92:93]
  s_and_b64 s[86:87], s[70:71], s[94:95]
  s_and_b64 s[80:81], s[80:81], s[92:93]
  s_and_b64 s[88:89], s[72:73], s[94:95]
  s_and_b64 s[82:83], s[82:83], s[92:93]
  s_and_b64 s[90:91], s[74:75], s[94:95]
  s_barrier
  ds_read_b64_tr_b16 v[160:161], v41 offset:24576
  ds_read_b64_tr_b16 v[162:163], v41 offset:25088
  ds_read_b64_tr_b16 v[164:165], v41 offset:32768
  ds_read_b64_tr_b16 v[166:167], v41 offset:33280
  ds_read_b64_tr_b16 v[168:169], v41 offset:40960
  ds_read_b64_tr_b16 v[170:171], v41 offset:41472
  ds_read_b128 v[136:139], v52 offset:0
  ds_read_b128 v[140:143], v37 offset:16384
  ds_read_b128 v[144:147], v37 offset:18432
  ds_read_b128 v[148:151], v37 offset:20480
  ds_read_b128 v[152:155], v37 offset:22528
  ds_read_b128 v[156:159], v39 offset:16384
  s_waitcnt lgkmcnt(0)
  v_mfma_f32_16x16x32_bf16 v[56:59], v[160:163], v[136:139], v[56:59]
  ds_read_b64_tr_b16 v[196:197], v41 offset:28672
  v_mfma_f32_16x16x32_bf16 v[76:79], v[164:167], v[136:139], v[76:79]
  ds_read_b64_tr_b16 v[198:199], v41 offset:29184
  v_mfma_f32_16x16x32_bf16 v[96:99], v[136:139], v[168:171], v[96:99]
  ds_read_b64_tr_b16 v[200:201], v41 offset:36864
  v_mfma_f32_16x16x32_bf16 v[60:63], v[160:163], v[140:143], v[60:63]
  ds_read_b64_tr_b16 v[202:203], v41 offset:37376
  v_mfma_f32_16x16x32_bf16 v[80:83], v[164:167], v[140:143], v[80:83]
  ds_read_b64_tr_b16 v[204:205], v41 offset:45056
  v_mfma_f32_16x16x32_bf16 v[100:103], v[140:143], v[168:171], v[100:103]
  ds_read_b64_tr_b16 v[206:207], v41 offset:45568
  v_mfma_f32_16x16x32_bf16 v[64:67], v[160:163], v[144:147], v[64:67]
  ds_read_b128 v[172:175], v53 offset:0
  v_mfma_f32_16x16x32_bf16 v[84:87], v[164:167], v[144:147], v[84:87]
  ds_read_b128 v[176:179], v38 offset:16384
  v_mfma_f32_16x16x32_bf16 v[104:107], v[144:147], v[168:171], v[104:107]
  ds_read_b128 v[180:183], v38 offset:18432
  v_mfma_f32_16x16x32_bf16 v[68:71], v[160:163], v[148:151], v[68:71]
  ds_read_b128 v[184:187], v38 offset:20480
  v_mfma_f32_16x16x32_bf16 v[88:91], v[164:167], v[148:151], v[88:91]
  ds_read_b128 v[188:191], v38 offset:22528
  v_mfma_f32_16x16x32_bf16 v[108:111], v[148:151], v[168:171], v[108:111]
  ds_read_b128 v[192:195], v40 offset:16384
  v_mfma_f32_16x16x32_bf16 v[72:75], v[160:163], v[152:155], v[72:75]
  v_mfma_f32_16x16x32_bf16 v[92:95], v[164:167], v[152:155], v[92:95]
  v_mfma_f32_16x16x32_bf16 v[112:115], v[152:155], v[168:171], v[112:115]
  v_mfma_f32_16x16x32_bf16 v[124:127], v[24:27], v[136:139], v[124:127]
  v_mfma_f32_16x16x32_bf16 v[128:131], v[136:139], v[136:139], v[128:131]
  v_mfma_f32_16x16x32_bf16 v[116:119], v[24:27], v[156:159], v[116:119]
  v_mfma_f32_16x16x32_bf16 v[120:123], v[156:159], v[156:159], v[120:123]
  s_waitcnt lgkmcnt(0)
  v_mfma_f32_16x16x32_bf16 v[56:59], v[196:199], v[172:175], v[56:59]
  v_mfma_f32_16x16x32_bf16 v[76:79], v[200:203], v[172:175], v[76:79]
  v_mfma_f32_16x16x32_bf16 v[96:99], v[172:175], v[204:207], v[96:99]
  v_mfma_f32_16x16x32_bf16 v[60:63], v[196:199], v[176:179], v[60:63]
  v_mfma_f32_16x16x32_bf16 v[80:83], v[200:203], v[176:179], v[80:83]
  v_mfma_f32_16x16x32_bf16 v[100:103], v[176:179], v[204:207], v[100:103]
  s_barrier
  v_mfma_f32_16x16x32_bf16 v[64:67], v[196:199], v[180:183], v[64:67]
  ds_read_b64_tr_b16 v[160:161], v41 offset:57344
  v_mfma_f32_16x16x32_bf16 v[84:87], v[200:203], v[180:183], v[84:87]
  ds_read_b64_tr_b16 v[162:163], v41 offset:57856
  v_mfma_f32_16x16x32_bf16 v[104:107], v[180:183], v[204:207], v[104:107]
  ds_read_b64_tr_b16 v[164:165], v50 offset:0
  v_mfma_f32_16x16x32_bf16 v[68:71], v[196:199], v[184:187], v[68:71]
  ds_read_b64_tr_b16 v[166:167], v50 offset:512
  v_mfma_f32_16x16x32_bf16 v[88:91], v[200:203], v[184:187], v[88:91]
  ds_read_b64_tr_b16 v[168:169], v50 offset:8192
  v_mfma_f32_16x16x32_bf16 v[108:111], v[184:187], v[204:207], v[108:111]
  ds_read_b64_tr_b16 v[170:171], v50 offset:8704
  v_mfma_f32_16x16x32_bf16 v[72:75], v[196:199], v[188:191], v[72:75]
  ds_read_b128 v[136:139], v54 offset:0
  v_mfma_f32_16x16x32_bf16 v[92:95], v[200:203], v[188:191], v[92:95]
  ds_read_b128 v[140:143], v37 offset:49152
  v_mfma_f32_16x16x32_bf16 v[112:115], v[188:191], v[204:207], v[112:115]
  ds_read_b128 v[144:147], v37 offset:51200
  v_mfma_f32_16x16x32_bf16 v[124:127], v[24:27], v[172:175], v[124:127]
  ds_read_b128 v[148:151], v37 offset:53248
  v_mfma_f32_16x16x32_bf16 v[128:131], v[172:175], v[172:175], v[128:131]
  ds_read_b128 v[152:155], v37 offset:55296
  v_mfma_f32_16x16x32_bf16 v[116:119], v[24:27], v[192:195], v[116:119]
  ds_read_b128 v[156:159], v39 offset:49152
  v_mfma_f32_16x16x32_bf16 v[120:123], v[192:195], v[192:195], v[120:123]
  s_waitcnt lgkmcnt(0)
  v_mfma_f32_16x16x32_bf16 v[56:59], v[160:163], v[136:139], v[56:59]
  ds_read_b64_tr_b16 v[196:197], v41 offset:61440
  v_mfma_f32_16x16x32_bf16 v[76:79], v[164:167], v[136:139], v[76:79]
  ds_read_b64_tr_b16 v[198:199], v41 offset:61952
  v_mfma_f32_16x16x32_bf16 v[96:99], v[136:139], v[168:171], v[96:99]
  ds_read_b64_tr_b16 v[200:201], v50 offset:4096
  v_mfma_f32_16x16x32_bf16 v[60:63], v[160:163], v[140:143], v[60:63]
  ds_read_b64_tr_b16 v[202:203], v50 offset:4608
  v_mfma_f32_16x16x32_bf16 v[80:83], v[164:167], v[140:143], v[80:83]
  ds_read_b64_tr_b16 v[204:205], v50 offset:12288
  v_mfma_f32_16x16x32_bf16 v[100:103], v[140:143], v[168:171], v[100:103]
  ds_read_b64_tr_b16 v[206:207], v50 offset:12800
  v_mfma_f32_16x16x32_bf16 v[64:67], v[160:163], v[144:147], v[64:67]
  ds_read_b128 v[172:175], v55 offset:0
  v_mfma_f32_16x16x32_bf16 v[84:87], v[164:167], v[144:147], v[84:87]
  ds_read_b128 v[176:179], v38 offset:49152
  v_mfma_f32_16x16x32_bf16 v[104:107], v[144:147], v[168:171], v[104:107]
  ds_read_b128 v[180:183], v38 offset:51200
  v_mfma_f32_16x16x32_bf16 v[68:71], v[160:163], v[148:151], v[68:71]
  ds_read_b128 v[184:187], v38 offset:53248
  v_mfma_f32_16x16x32_bf16 v[88:91], v[164:167], v[148:151], v[88:91]
  ds_read_b128 v[188:191], v38 offset:55296
  v_mfma_f32_16x16x32_bf16 v[108:111], v[148:151], v[168:171], v[108:111]
  ds_read_b128 v[192:195], v40 offset:49152
  v_mfma_f32_16x16x32_bf16 v[72:75], v[160:163], v[152:155], v[72:75]
  v_mfma_f32_16x16x32_bf16 v[92:95], v[164:167], v[152:155], v[92:95]
  v_mfma_f32_16x16x32_bf16 v[112:115], v[152:155], v[168:171], v[112:115]
  v_mfma_f32_16x16x32_bf16 v[124:127], v[24:27], v[136:139], v[124:127]
  v_mfma_f32_16x16x32_bf16 v[128:131], v[136:139], v[136:139], v[128:131]
  v_mfma_f32_16x16x32_bf16 v[116:119], v[24:27], v[156:159], v[116:119]
  v_mfma_f32_16x16x32_bf16 v[120:123], v[156:159], v[156:159], v[120:123]
  s_waitcnt lgkmcnt(0)
  v_mfma_f32_16x16x32_bf16 v[56:59], v[196:199], v[172:175], v[56:59]
  v_mfma_f32_16x16x32_bf16 v[76:79], v[200:203], v[172:175], v[76:79]
  v_mfma_f32_16x16x32_bf16 v[96:99], v[172:175], v[204:207], v[96:99]
  v_mfma_f32_16x16x32_bf16 v[60:63], v[196:199], v[176:179], v[60:63]
  v_mfma_f32_16x16x32_bf16 v[80:83], v[200:203], v[176:179], v[80:83]
  v_mfma_f32_16x16x32_bf16 v[100:103], v[176:179], v[204:207], v[100:103]
  s_barrier
  v_mfma_f32_16x16x32_bf16 v[64:67], v[196:199], v[180:183], v[64:67]
  ds_read_b64_tr_b16 v[160:161], v50 offset:24576
  v_mfma_f32_16x16x32_bf16 v[84:87], v[200:203], v[180:183], v[84:87]
  ds_read_b64_tr_b16 v[162:163], v50 offset:25088
  v_mfma_f32_16x16x32_bf16 v[104:107], v[180:183], v[204:207], v[104:107]
  ds_read_b64_tr_b16 v[164:165], v50 offset:32768
  v_mfma_f32_16x16x32_bf16 v[68:71], v[196:199], v[184:187], v[68:71]
  ds_read_b64_tr_b16 v[166:167], v50 offset:33280
  v_mfma_f32_16x16x32_bf16 v[88:91], v[200:203], v[184:187], v[88:91]
  ds_read_b64_tr_b16 v[168:169], v50 offset:40960
  v_mfma_f32_16x16x32_bf16 v[108:111], v[184:187], v[204:207], v[108:111]
  ds_read_b64_tr_b16 v[170:171], v50 offset:41472
  v_mfma_f32_16x16x32_bf16 v[72:75], v[196:199], v[188:191], v[72:75]
  ds_read_b128 v[136:139], v52 offset:256
  v_mfma_f32_16x16x32_bf16 v[92:95], v[200:203], v[188:191], v[92:95]
  ds_read_b128 v[140:143], v42 offset:16384
  v_mfma_f32_16x16x32_bf16 v[112:115], v[188:191], v[204:207], v[112:115]
  ds_read_b128 v[144:147], v42 offset:18432
  v_mfma_f32_16x16x32_bf16 v[124:127], v[24:27], v[172:175], v[124:127]
  ds_read_b128 v[148:151], v42 offset:20480
  v_mfma_f32_16x16x32_bf16 v[128:131], v[172:175], v[172:175], v[128:131]
  ds_read_b128 v[152:155], v42 offset:22528
  v_mfma_f32_16x16x32_bf16 v[116:119], v[24:27], v[192:195], v[116:119]
  ds_read_b128 v[156:159], v46 offset:16384
  v_mfma_f32_16x16x32_bf16 v[120:123], v[192:195], v[192:195], v[120:123]
  s_waitcnt lgkmcnt(0)
  v_mfma_f32_16x16x32_bf16 v[56:59], v[160:163], v[136:139], v[56:59]
  ds_read_b64_tr_b16 v[196:197], v50 offset:28672
  v_mfma_f32_16x16x32_bf16 v[76:79], v[164:167], v[136:139], v[76:79]
  ds_read_b64_tr_b16 v[198:199], v50 offset:29184
  v_mfma_f32_16x16x32_bf16 v[96:99], v[136:139], v[168:171], v[96:99]
  ds_read_b64_tr_b16 v[200:201], v50 offset:36864
  v_mfma_f32_16x16x32_bf16 v[60:63], v[160:163], v[140:143], v[60:63]
  ds_read_b64_tr_b16 v[202:203], v50 offset:37376
  v_mfma_f32_16x16x32_bf16 v[80:83], v[164:167], v[140:143], v[80:83]
  ds_read_b64_tr_b16 v[204:205], v50 offset:45056
  v_mfma_f32_16x16x32_bf16 v[100:103], v[140:143], v[168:171], v[100:103]
  ds_read_b64_tr_b16 v[206:207], v50 offset:45568
  v_mfma_f32_16x16x32_bf16 v[64:67], v[160:163], v[144:147], v[64:67]
  ds_read_b128 v[172:175], v53 offset:256
  v_mfma_f32_16x16x32_bf16 v[84:87], v[164:167], v[144:147], v[84:87]
  ds_read_b128 v[176:179], v44 offset:16384
  v_mfma_f32_16x16x32_bf16 v[104:107], v[144:147], v[168:171], v[104:107]
  ds_read_b128 v[180:183], v44 offset:18432
  v_mfma_f32_16x16x32_bf16 v[68:71], v[160:163], v[148:151], v[68:71]
  ds_read_b128 v[184:187], v44 offset:20480
  v_mfma_f32_16x16x32_bf16 v[88:91], v[164:167], v[148:151], v[88:91]
  ds_read_b128 v[188:191], v44 offset:22528
  v_mfma_f32_16x16x32_bf16 v[108:111], v[148:151], v[168:171], v[108:111]
  ds_read_b128 v[192:195], v48 offset:16384
  v_mfma_f32_16x16x32_bf16 v[72:75], v[160:163], v[152:155], v[72:75]
  v_mfma_f32_16x16x32_bf16 v[92:95], v[164:167], v[152:155], v[92:95]
  v_mfma_f32_16x16x32_bf16 v[112:115], v[152:155], v[168:171], v[112:115]
  v_mfma_f32_16x16x32_bf16 v[124:127], v[24:27], v[136:139], v[124:127]
  v_mfma_f32_16x16x32_bf16 v[128:131], v[136:139], v[136:139], v[128:131]
  v_mfma_f32_16x16x32_bf16 v[116:119], v[24:27], v[156:159], v[116:119]
  v_mfma_f32_16x16x32_bf16 v[120:123], v[156:159], v[156:159], v[120:123]
  s_waitcnt lgkmcnt(0)
  v_mfma_f32_16x16x32_bf16 v[56:59], v[196:199], v[172:175], v[56:59]
  v_mfma_f32_16x16x32_bf16 v[76:79], v[200:203], v[172:175], v[76:79]
  v_mfma_f32_16x16x32_bf16 v[96:99], v[172:175], v[204:207], v[96:99]
  v_mfma_f32_16x16x32_bf16 v[60:63], v[196:199], v[176:179], v[60:63]
  v_mfma_f32_16x16x32_bf16 v[80:83], v[200:203], v[176:179], v[80:83]
  v_mfma_f32_16x16x32_bf16 v[100:103], v[176:179], v[204:207], v[100:103]
  s_barrier
  v_mfma_f32_16x16x32_bf16 v[64:67], v[196:199], v[180:183], v[64:67]
  ds_read_b64_tr_b16 v[160:161], v41 offset:24576
  v_mfma_f32_16x16x32_bf16 v[84:87], v[200:203], v[180:183], v[84:87]
  ds_read_b64_tr_b16 v[162:163], v41 offset:25088
  v_mfma_f32_16x16x32_bf16 v[104:107], v[180:183], v[204:207], v[104:107]
  ds_read_b64_tr_b16 v[164:165], v41 offset:32768
  v_mfma_f32_16x16x32_bf16 v[68:71], v[196:199], v[184:187], v[68:71]
  ds_read_b64_tr_b16 v[166:167], v41 offset:33280
  v_mfma_f32_16x16x32_bf16 v[88:91], v[200:203], v[184:187], v[88:91]
  ds_read_b64_tr_b16 v[168:169], v41 offset:40960
  v_mfma_f32_16x16x32_bf16 v[108:111], v[184:187], v[204:207], v[108:111]
  ds_read_b64_tr_b16 v[170:171], v41 offset:41472
  v_mfma_f32_16x16x32_bf16 v[72:75], v[196:199], v[188:191], v[72:75]
  ds_read_b128 v[136:139], v54 offset:256
  v_mfma_f32_16x16x32_bf16 v[92:95], v[200:203], v[188:191], v[92:95]
  ds_read_b128 v[140:143], v37 offset:16384
  v_mfma_f32_16x16x32_bf16 v[112:115], v[188:191], v[204:207], v[112:115]
  ds_read_b128 v[144:147], v37 offset:18432
  v_mfma_f32_16x16x32_bf16 v[124:127], v[24:27], v[172:175], v[124:127]
  ds_read_b128 v[148:151], v37 offset:20480
  v_mfma_f32_16x16x32_bf16 v[128:131], v[172:175], v[172:175], v[128:131]
  ds_read_b128 v[152:155], v37 offset:22528
  v_mfma_f32_16x16x32_bf16 v[116:119], v[24:27], v[192:195], v[116:119]
  ds_read_b128 v[156:159], v39 offset:16384
  v_mfma_f32_16x16x32_bf16 v[120:123], v[192:195], v[192:195], v[120:123]
  s_waitcnt lgkmcnt(0)
  v_mfma_f32_16x16x32_bf16 v[56:59], v[160:163], v[136:139], v[56:59]
  ds_read_b64_tr_b16 v[196:197], v41 offset:28672
  v_mfma_f32_16x16x32_bf16 v[76:79], v[164:167], v[136:139], v[76:79]
  ds_read_b64_tr_b16 v[198:199], v41 offset:29184
  v_lshlrev_b32 v6, 3, v4
  v_lshl_add_u32 v7, v3, 11, v6
  s_lshl_b32 s52, s40, 16
  s_lshr_b32 s53, s4, 1
  s_lshl_b32 s53, s53, 15
  s_add_u32 s52, s52, s53
  s_lshl_b32 s53, s41, 7
  s_add_u32 s52, s52, s53
  s_and_b32 s53, s4, 1
  s_lshl_b32 s53, s53, 6
  s_add_u32 s52, s52, s53
  buffer_load_dwordx2 v[28:29], v7, s[8:11], s52 offen offset:0
  buffer_load_dwordx2 v[30:31], v7, s[8:11], s52 offen offset:32
  buffer_load_dwordx2 v[32:33], v7, s[8:11], s52 offen offset:1024
  buffer_load_dwordx2 v[34:35], v7, s[8:11], s52 offen offset:1056
  v_mov_b32 v36, 1
  v_mfma_f32_16x16x32_bf16 v[96:99], v[136:139], v[168:171], v[96:99]
  ds_read_b64_tr_b16 v[200:201], v41 offset:36864
  v_mfma_f32_16x16x32_bf16 v[60:63], v[160:163], v[140:143], v[60:63]
  ds_read_b64_tr_b16 v[202:203], v41 offset:37376
  v_mfma_f32_16x16x32_bf16 v[80:83], v[164:167], v[140:143], v[80:83]
  ds_read_b64_tr_b16 v[204:205], v41 offset:45056
  v_mfma_f32_16x16x32_bf16 v[100:103], v[140:143], v[168:171], v[100:103]
  ds_read_b64_tr_b16 v[206:207], v41 offset:45568
  v_mfma_f32_16x16x32_bf16 v[64:67], v[160:163], v[144:147], v[64:67]
  ds_read_b128 v[172:175], v55 offset:256
  v_mfma_f32_16x16x32_bf16 v[84:87], v[164:167], v[144:147], v[84:87]
  ds_read_b128 v[176:179], v38 offset:16384
  v_mfma_f32_16x16x32_bf16 v[104:107], v[144:147], v[168:171], v[104:107]
  ds_read_b128 v[180:183], v38 offset:18432
  v_mfma_f32_16x16x32_bf16 v[68:71], v[160:163], v[148:151], v[68:71]
  ds_read_b128 v[184:187], v38 offset:20480
  v_mfma_f32_16x16x32_bf16 v[88:91], v[164:167], v[148:151], v[88:91]
  ds_read_b128 v[188:191], v38 offset:22528
  v_mfma_f32_16x16x32_bf16 v[108:111], v[148:151], v[168:171], v[108:111]
  ds_read_b128 v[192:195], v40 offset:16384
  v_mfma_f32_16x16x32_bf16 v[72:75], v[160:163], v[152:155], v[72:75]
  v_mfma_f32_16x16x32_bf16 v[92:95], v[164:167], v[152:155], v[92:95]
  v_mfma_f32_16x16x32_bf16 v[112:115], v[152:155], v[168:171], v[112:115]
  v_mfma_f32_16x16x32_bf16 v[124:127], v[24:27], v[136:139], v[124:127]
  v_mfma_f32_16x16x32_bf16 v[128:131], v[136:139], v[136:139], v[128:131]
  v_mfma_f32_16x16x32_bf16 v[116:119], v[24:27], v[156:159], v[116:119]
  v_mfma_f32_16x16x32_bf16 v[120:123], v[156:159], v[156:159], v[120:123]
  s_waitcnt lgkmcnt(0)
  v_mfma_f32_16x16x32_bf16 v[56:59], v[196:199], v[172:175], v[56:59]
  v_mfma_f32_16x16x32_bf16 v[76:79], v[200:203], v[172:175], v[76:79]
  v_mfma_f32_16x16x32_bf16 v[96:99], v[172:175], v[204:207], v[96:99]
  v_mfma_f32_16x16x32_bf16 v[60:63], v[196:199], v[176:179], v[60:63]
  v_mfma_f32_16x16x32_bf16 v[80:83], v[200:203], v[176:179], v[80:83]
  v_mfma_f32_16x16x32_bf16 v[100:103], v[176:179], v[204:207], v[100:103]
  s_barrier
  v_mfma_f32_16x16x32_bf16 v[64:67], v[196:199], v[180:183], v[64:67]
  ds_read_b64_tr_b16 v[160:161], v41 offset:57344
  v_mfma_f32_16x16x32_bf16 v[84:87], v[200:203], v[180:183], v[84:87]
  ds_read_b64_tr_b16 v[162:163], v41 offset:57856
  v_mfma_f32_16x16x32_bf16 v[104:107], v[180:183], v[204:207], v[104:107]
  ds_read_b64_tr_b16 v[164:165], v50 offset:0
  v_mfma_f32_16x16x32_bf16 v[68:71], v[196:199], v[184:187], v[68:71]
  ds_read_b64_tr_b16 v[166:167], v50 offset:512
  v_mfma_f32_16x16x32_bf16 v[88:91], v[200:203], v[184:187], v[88:91]
  ds_read_b64_tr_b16 v[168:169], v50 offset:8192
  v_mfma_f32_16x16x32_bf16 v[108:111], v[184:187], v[204:207], v[108:111]
  ds_read_b64_tr_b16 v[170:171], v50 offset:8704
  v_mfma_f32_16x16x32_bf16 v[72:75], v[196:199], v[188:191], v[72:75]
  ds_read_b128 v[136:139], v52 offset:512
  v_mfma_f32_16x16x32_bf16 v[92:95], v[200:203], v[188:191], v[92:95]
  ds_read_b128 v[140:143], v37 offset:49152
  v_mfma_f32_16x16x32_bf16 v[112:115], v[188:191], v[204:207], v[112:115]
  ds_read_b128 v[144:147], v37 offset:51200
  v_mfma_f32_16x16x32_bf16 v[124:127], v[24:27], v[172:175], v[124:127]
  ds_read_b128 v[148:151], v37 offset:53248
  v_mfma_f32_16x16x32_bf16 v[128:131], v[172:175], v[172:175], v[128:131]
  ds_read_b128 v[152:155], v37 offset:55296
  v_mfma_f32_16x16x32_bf16 v[116:119], v[24:27], v[192:195], v[116:119]
  ds_read_b128 v[156:159], v39 offset:49152
  v_mfma_f32_16x16x32_bf16 v[120:123], v[192:195], v[192:195], v[120:123]
  s_waitcnt lgkmcnt(0)
  s_or_b32 s58, s3, s7
  s_cmp_lg_u32 s58, 0
  s_cbranch_scc1 L_CHK0_DONE
  v_lshlrev_b32 v7, 2, v2
  buffer_load_dword v19, v7, s[32:35], 0 offen sc1
L_CHK0_DONE:
  v_mfma_f32_16x16x32_bf16 v[56:59], v[160:163], v[136:139], v[56:59]
  ds_read_b64_tr_b16 v[196:197], v41 offset:61440
  v_mfma_f32_16x16x32_bf16 v[76:79], v[164:167], v[136:139], v[76:79]
  ds_read_b64_tr_b16 v[198:199], v41 offset:61952
  v_mfma_f32_16x16x32_bf16 v[96:99], v[136:139], v[168:171], v[96:99]
  ds_read_b64_tr_b16 v[200:201], v50 offset:4096
  v_mfma_f32_16x16x32_bf16 v[60:63], v[160:163], v[140:143], v[60:63]
  ds_read_b64_tr_b16 v[202:203], v50 offset:4608
  v_mfma_f32_16x16x32_bf16 v[80:83], v[164:167], v[140:143], v[80:83]
  ds_read_b64_tr_b16 v[204:205], v50 offset:12288
  v_mfma_f32_16x16x32_bf16 v[100:103], v[140:143], v[168:171], v[100:103]
  ds_read_b64_tr_b16 v[206:207], v50 offset:12800
  v_mfma_f32_16x16x32_bf16 v[64:67], v[160:163], v[144:147], v[64:67]
  ds_read_b128 v[172:175], v53 offset:512
  v_mfma_f32_16x16x32_bf16 v[84:87], v[164:167], v[144:147], v[84:87]
  ds_read_b128 v[176:179], v38 offset:49152
  v_mfma_f32_16x16x32_bf16 v[104:107], v[144:147], v[168:171], v[104:107]
  ds_read_b128 v[180:183], v38 offset:51200
  v_mfma_f32_16x16x32_bf16 v[68:71], v[160:163], v[148:151], v[68:71]
  ds_read_b128 v[184:187], v38 offset:53248
  v_mfma_f32_16x16x32_bf16 v[88:91], v[164:167], v[148:151], v[88:91]
  ds_read_b128 v[188:191], v38 offset:55296
  v_mfma_f32_16x16x32_bf16 v[108:111], v[148:151], v[168:171], v[108:111]
  ds_read_b128 v[192:195], v40 offset:49152
  v_mfma_f32_16x16x32_bf16 v[72:75], v[160:163], v[152:155], v[72:75]
  v_mfma_f32_16x16x32_bf16 v[92:95], v[164:167], v[152:155], v[92:95]
  v_mfma_f32_16x16x32_bf16 v[112:115], v[152:155], v[168:171], v[112:115]
  v_mfma_f32_16x16x32_bf16 v[124:127], v[24:27], v[136:139], v[124:127]
  v_mfma_f32_16x16x32_bf16 v[128:131], v[136:139], v[136:139], v[128:131]
  v_mfma_f32_16x16x32_bf16 v[116:119], v[24:27], v[156:159], v[116:119]
  v_mfma_f32_16x16x32_bf16 v[120:123], v[156:159], v[156:159], v[120:123]
  s_waitcnt lgkmcnt(0)
  v_mfma_f32_16x16x32_bf16 v[56:59], v[196:199], v[172:175], v[56:59]
  v_mfma_f32_16x16x32_bf16 v[76:79], v[200:203], v[172:175], v[76:79]
  v_mfma_f32_16x16x32_bf16 v[96:99], v[172:175], v[204:207], v[96:99]
  v_mfma_f32_16x16x32_bf16 v[60:63], v[196:199], v[176:179], v[60:63]
  v_mfma_f32_16x16x32_bf16 v[80:83], v[200:203], v[176:179], v[80:83]
  v_mfma_f32_16x16x32_bf16 v[100:103], v[176:179], v[204:207], v[100:103]
  s_barrier
  v_mfma_f32_16x16x32_bf16 v[64:67], v[196:199], v[180:183], v[64:67]
  ds_read_b64_tr_b16 v[160:161], v50 offset:24576
  v_mfma_f32_16x16x32_bf16 v[84:87], v[200:203], v[180:183], v[84:87]
  ds_read_b64_tr_b16 v[162:163], v50 offset:25088
  v_mfma_f32_16x16x32_bf16 v[104:107], v[180:183], v[204:207], v[104:107]
  ds_read_b64_tr_b16 v[164:165], v50 offset:32768
  v_mfma_f32_16x16x32_bf16 v[68:71], v[196:199], v[184:187], v[68:71]
  ds_read_b64_tr_b16 v[166:167], v50 offset:33280
  v_mfma_f32_16x16x32_bf16 v[88:91], v[200:203], v[184:187], v[88:91]
  ds_read_b64_tr_b16 v[168:169], v50 offset:40960
  v_mfma_f32_16x16x32_bf16 v[108:111], v[184:187], v[204:207], v[108:111]
  ds_read_b64_tr_b16 v[170:171], v50 offset:41472
  v_mfma_f32_16x16x32_bf16 v[72:75], v[196:199], v[188:191], v[72:75]
  ds_read_b128 v[136:139], v54 offset:512
  v_mfma_f32_16x16x32_bf16 v[92:95], v[200:203], v[188:191], v[92:95]
  ds_read_b128 v[140:143], v42 offset:16384
  v_mfma_f32_16x16x32_bf16 v[112:115], v[188:191], v[204:207], v[112:115]
  ds_read_b128 v[144:147], v42 offset:18432
  v_mfma_f32_16x16x32_bf16 v[124:127], v[24:27], v[172:175], v[124:127]
  ds_read_b128 v[148:151], v42 offset:20480
  v_mfma_f32_16x16x32_bf16 v[128:131], v[172:175], v[172:175], v[128:131]
  ds_read_b128 v[152:155], v42 offset:22528
  v_mfma_f32_16x16x32_bf16 v[116:119], v[24:27], v[192:195], v[116:119]
  ds_read_b128 v[156:159], v46 offset:16384
  v_mfma_f32_16x16x32_bf16 v[120:123], v[192:195], v[192:195], v[120:123]
  s_waitcnt lgkmcnt(0)
  s_or_b32 s58, s3, s7
  s_cmp_lg_u32 s58, 0
  s_cbranch_scc1 L_CHK_DONE
  s_mov_b32 s97, 0
  s_waitcnt vmcnt(0)
L_CHK_LOOP:
  s_or_b32 s58, s5, 16
  s_mov_b32 s59, 0
  v_and_b32 v6, 0xf7f7f7f7, v19
  v_mov_b32 v8, 0
  v_bfe_u32 v7, v6, 0, 8
  v_cmp_eq_u32 vcc, s58, v7
  s_nop 0
  s_bcnt1_i32_b64 s96, vcc
  v_addc_co_u32 v8, vcc, 0, v8, vcc
  s_add_u32 s59, s59, s96
  v_bfe_u32 v7, v6, 8, 8
  v_cmp_eq_u32 vcc, s58, v7
  s_nop 0
  s_bcnt1_i32_b64 s96, vcc
  v_addc_co_u32 v8, vcc, 0, v8, vcc
  s_add_u32 s59, s59, s96
  v_bfe_u32 v7, v6, 16, 8
  v_cmp_eq_u32 vcc, s58, v7
  s_nop 0
  s_bcnt1_i32_b64 s96, vcc
  v_addc_co_u32 v8, vcc, 0, v8, vcc
  s_add_u32 s59, s59, s96
  v_bfe_u32 v7, v6, 24, 8
  v_cmp_eq_u32 vcc, s58, v7
  s_nop 0
  s_bcnt1_i32_b64 s96, vcc
  v_addc_co_u32 v8, vcc, 0, v8, vcc
  s_add_u32 s59, s59, s96
  s_nop 0
  v_add_u32_dpp v8, v8, v8 quad_perm:[1,0,3,2] row_mask:0xf bank_mask:0xf
  v_cmp_ne_u32 vcc, 1, v8
  s_nop 0
  s_cmp_lg_u64 vcc, 0
  s_cselect_b32 s58, 1, 0
  s_cmp_eq_u32 s59, 32
  s_cbranch_scc1 L_CHK_GOT
  s_add_u32 s97, s97, 1
  s_cmp_gt_u32 s97, 20000
  s_cbranch_scc1 L_CHK_GOT
  v_lshlrev_b32 v7, 2, v2
  buffer_load_dword v19, v7, s[32:35], 0 offen sc1
  s_waitcnt vmcnt(0)
  s_branch L_CHK_LOOP
L_CHK_GOT:
  v_mov_b32 v6, s58
  v_mov_b32 v7, 162688
  ds_write_b32 v7, v6
L_CHK_DONE:
  v_mfma_f32_16x16x32_bf16 v[56:59], v[160:163], v[136:139], v[56:59]
  ds_read_b64_tr_b16 v[196:197], v50 offset:28672
  v_mfma_f32_16x16x32_bf16 v[76:79], v[164:167], v[136:139], v[76:79]
  ds_read_b64_tr_b16 v[198:199], v50 offset:29184
  v_mfma_f32_16x16x32_bf16 v[96:99], v[136:139], v[168:171], v[96:99]
  ds_read_b64_tr_b16 v[200:201], v50 offset:36864
  v_mfma_f32_16x16x32_bf16 v[60:63], v[160:163], v[140:143], v[60:63]
  ds_read_b64_tr_b16 v[202:203], v50 offset:37376
  v_mfma_f32_16x16x32_bf16 v[80:83], v[164:167], v[140:143], v[80:83]
  ds_read_b64_tr_b16 v[204:205], v50 offset:45056
  v_mfma_f32_16x16x32_bf16 v[100:103], v[140:143], v[168:171], v[100:103]
  ds_read_b64_tr_b16 v[206:207], v50 offset:45568
  v_mfma_f32_16x16x32_bf16 v[64:67], v[160:163], v[144:147], v[64:67]
  ds_read_b128 v[172:175], v55 offset:512
  v_mfma_f32_16x16x32_bf16 v[84:87], v[164:167], v[144:147], v[84:87]
  ds_read_b128 v[176:179], v44 offset:16384
  v_mfma_f32_16x16x32_bf16 v[104:107], v[144:147], v[168:171], v[104:107]
  ds_read_b128 v[180:183], v44 offset:18432
  v_mfma_f32_16x16x32_bf16 v[68:71], v[160:163], v[148:151], v[68:71]
  ds_read_b128 v[184:187], v44 offset:20480
  v_mfma_f32_16x16x32_bf16 v[88:91], v[164:167], v[148:151], v[88:91]
  ds_read_b128 v[188:191], v44 offset:22528
  v_mfma_f32_16x16x32_bf16 v[108:111], v[148:151], v[168:171], v[108:111]
  ds_read_b128 v[192:195], v48 offset:16384
  v_mfma_f32_16x16x32_bf16 v[72:75], v[160:163], v[152:155], v[72:75]
  v_mfma_f32_16x16x32_bf16 v[92:95], v[164:167], v[152:155], v[92:95]
  v_mfma_f32_16x16x32_bf16 v[112:115], v[152:155], v[168:171], v[112:115]
  v_mfma_f32_16x16x32_bf16 v[124:127], v[24:27], v[136:139], v[124:127]
  v_mfma_f32_16x16x32_bf16 v[128:131], v[136:139], v[136:139], v[128:131]
  v_mfma_f32_16x16x32_bf16 v[116:119], v[24:27], v[156:159], v[116:119]
  v_mfma_f32_16x16x32_bf16 v[120:123], v[156:159], v[156:159], v[120:123]
  s_waitcnt lgkmcnt(0)
  v_mfma_f32_16x16x32_bf16 v[56:59], v[196:199], v[172:175], v[56:59]
  v_mfma_f32_16x16x32_bf16 v[76:79], v[200:203], v[172:175], v[76:79]
  v_mfma_f32_16x16x32_bf16 v[96:99], v[172:175], v[204:207], v[96:99]
  v_mfma_f32_16x16x32_bf16 v[60:63], v[196:199], v[176:179], v[60:63]
  v_mfma_f32_16x16x32_bf16 v[80:83], v[200:203], v[176:179], v[80:83]
  v_mfma_f32_16x16x32_bf16 v[100:103], v[176:179], v[204:207], v[100:103]
  s_barrier
  v_mfma_f32_16x16x32_bf16 v[64:67], v[196:199], v[180:183], v[64:67]
  ds_read_b64_tr_b16 v[160:161], v41 offset:24576
  v_mfma_f32_16x16x32_bf16 v[84:87], v[200:203], v[180:183], v[84:87]
  ds_read_b64_tr_b16 v[162:163], v41 offset:25088
  v_mfma_f32_16x16x32_bf16 v[104:107], v[180:183], v[204:207], v[104:107]
  ds_read_b64_tr_b16 v[164:165], v41 offset:32768
  v_mfma_f32_16x16x32_bf16 v[68:71], v[196:199], v[184:187], v[68:71]
  ds_read_b64_tr_b16 v[166:167], v41 offset:33280
  v_mfma_f32_16x16x32_bf16 v[88:91], v[200:203], v[184:187], v[88:91]
  ds_read_b64_tr_b16 v[168:169], v41 offset:40960
  v_mfma_f32_16x16x32_bf16 v[108:111], v[184:187], v[204:207], v[108:111]
  ds_read_b64_tr_b16 v[170:171], v41 offset:41472
  v_mfma_f32_16x16x32_bf16 v[72:75], v[196:199], v[188:191], v[72:75]
  ds_read_b128 v[136:139], v52 offset:768
  v_mfma_f32_16x16x32_bf16 v[92:95], v[200:203], v[188:191], v[92:95]
  ds_read_b128 v[140:143], v37 offset:16384
  v_mfma_f32_16x16x32_bf16 v[112:115], v[188:191], v[204:207], v[112:115]
  ds_read_b128 v[144:147], v37 offset:18432
  v_mfma_f32_16x16x32_bf16 v[124:127], v[24:27], v[172:175], v[124:127]
  ds_read_b128 v[148:151], v37 offset:20480
  v_mfma_f32_16x16x32_bf16 v[128:131], v[172:175], v[172:175], v[128:131]
  ds_read_b128 v[152:155], v37 offset:22528
  v_mfma_f32_16x16x32_bf16 v[116:119], v[24:27], v[192:195], v[116:119]
  ds_read_b128 v[156:159], v39 offset:16384
  v_mfma_f32_16x16x32_bf16 v[120:123], v[192:195], v[192:195], v[120:123]
  s_waitcnt lgkmcnt(0)
  v_mfma_f32_16x16x32_bf16 v[56:59], v[160:163], v[136:139], v[56:59]
  ds_read_b64_tr_b16 v[196:197], v41 offset:28672
  v_mfma_f32_16x16x32_bf16 v[76:79], v[164:167], v[136:139], v[76:79]
  ds_read_b64_tr_b16 v[198:199], v41 offset:29184
  v_mfma_f32_16x16x32_bf16 v[96:99], v[136:139], v[168:171], v[96:99]
  ds_read_b64_tr_b16 v[200:201], v41 offset:36864
  v_mfma_f32_16x16x32_bf16 v[60:63], v[160:163], v[140:143], v[60:63]
  ds_read_b64_tr_b16 v[202:203], v41 offset:37376
  v_mfma_f32_16x16x32_bf16 v[80:83], v[164:167], v[140:143], v[80:83]
  ds_read_b64_tr_b16 v[204:205], v41 offset:45056
  v_mfma_f32_16x16x32_bf16 v[100:103], v[140:143], v[168:171], v[100:103]
  ds_read_b64_tr_b16 v[206:207], v41 offset:45568
  v_mfma_f32_16x16x32_bf16 v[64:67], v[160:163], v[144:147], v[64:67]
  ds_read_b128 v[172:175], v53 offset:768
  v_mfma_f32_16x16x32_bf16 v[84:87], v[164:167], v[144:147], v[84:87]
  ds_read_b128 v[176:179], v38 offset:16384
  v_mfma_f32_16x16x32_bf16 v[104:107], v[144:147], v[168:171], v[104:107]
  ds_read_b128 v[180:183], v38 offset:18432
  v_mfma_f32_16x16x32_bf16 v[68:71], v[160:163], v[148:151], v[68:71]
  ds_read_b128 v[184:187], v38 offset:20480
  v_mfma_f32_16x16x32_bf16 v[88:91], v[164:167], v[148:151], v[88:91]
  ds_read_b128 v[188:191], v38 offset:22528
  v_mfma_f32_16x16x32_bf16 v[108:111], v[148:151], v[168:171], v[108:111]
  ds_read_b128 v[192:195], v40 offset:16384
  v_mfma_f32_16x16x32_bf16 v[72:75], v[160:163], v[152:155], v[72:75]
  v_mfma_f32_16x16x32_bf16 v[92:95], v[164:167], v[152:155], v[92:95]
  v_mfma_f32_16x16x32_bf16 v[112:115], v[152:155], v[168:171], v[112:115]
  v_mfma_f32_16x16x32_bf16 v[124:127], v[24:27], v[136:139], v[124:127]
  v_mfma_f32_16x16x32_bf16 v[128:131], v[136:139], v[136:139], v[128:131]
  v_mfma_f32_16x16x32_bf16 v[116:119], v[24:27], v[156:159], v[116:119]
  v_mfma_f32_16x16x32_bf16 v[120:123], v[156:159], v[156:159], v[120:123]
  s_waitcnt lgkmcnt(0)
  v_mfma_f32_16x16x32_bf16 v[56:59], v[196:199], v[172:175], v[56:59]
  v_mfma_f32_16x16x32_bf16 v[76:79], v[200:203], v[172:175], v[76:79]
  v_mfma_f32_16x16x32_bf16 v[96:99], v[172:175], v[204:207], v[96:99]
  v_mfma_f32_16x16x32_bf16 v[60:63], v[196:199], v[176:179], v[60:63]
  v_mfma_f32_16x16x32_bf16 v[80:83], v[200:203], v[176:179], v[80:83]
  v_mfma_f32_16x16x32_bf16 v[100:103], v[176:179], v[204:207], v[100:103]
  s_barrier
  v_mfma_f32_16x16x32_bf16 v[64:67], v[196:199], v[180:183], v[64:67]
  ds_read_b64_tr_b16 v[160:161], v41 offset:57344
  v_mfma_f32_16x16x32_bf16 v[84:87], v[200:203], v[180:183], v[84:87]
  ds_read_b64_tr_b16 v[162:163], v41 offset:57856
  v_mfma_f32_16x16x32_bf16 v[104:107], v[180:183], v[204:207], v[104:107]
  ds_read_b64_tr_b16 v[164:165], v50 offset:0
  v_mfma_f32_16x16x32_bf16 v[68:71], v[196:199], v[184:187], v[68:71]
  ds_read_b64_tr_b16 v[166:167], v50 offset:512
  v_mfma_f32_16x16x32_bf16 v[88:91], v[200:203], v[184:187], v[88:91]
  ds_read_b64_tr_b16 v[168:169], v50 offset:8192
  v_mfma_f32_16x16x32_bf16 v[108:111], v[184:187], v[204:207], v[108:111]
  ds_read_b64_tr_b16 v[170:171], v50 offset:8704
  v_mfma_f32_16x16x32_bf16 v[72:75], v[196:199], v[188:191], v[72:75]
  ds_read_b128 v[136:139], v54 offset:768
  v_mfma_f32_16x16x32_bf16 v[92:95], v[200:203], v[188:191], v[92:95]
  ds_read_b128 v[140:143], v37 offset:49152
  v_mfma_f32_16x16x32_bf16 v[112:115], v[188:191], v[204:207], v[112:115]
  ds_read_b128 v[144:147], v37 offset:51200
  v_mfma_f32_16x16x32_bf16 v[124:127], v[24:27], v[172:175], v[124:127]
  ds_read_b128 v[148:151], v37 offset:53248
  v_mfma_f32_16x16x32_bf16 v[128:131], v[172:175], v[172:175], v[128:131]
  ds_read_b128 v[152:155], v37 offset:55296
  v_mfma_f32_16x16x32_bf16 v[116:119], v[24:27], v[192:195], v[116:119]
  ds_read_b128 v[156:159], v39 offset:49152
  v_mfma_f32_16x16x32_bf16 v[120:123], v[192:195], v[192:195], v[120:123]
  s_waitcnt lgkmcnt(0)
  v_mfma_f32_16x16x32_bf16 v[56:59], v[160:163], v[136:139], v[56:59]
  ds_read_b64_tr_b16 v[196:197], v41 offset:61440
  v_mfma_f32_16x16x32_bf16 v[76:79], v[164:167], v[136:139], v[76:79]
  ds_read_b64_tr_b16 v[198:199], v41 offset:61952
  v_mfma_f32_16x16x32_bf16 v[96:99], v[136:139], v[168:171], v[96:99]
  ds_read_b64_tr_b16 v[200:201], v50 offset:4096
  v_mfma_f32_16x16x32_bf16 v[60:63], v[160:163], v[140:143], v[60:63]
  ds_read_b64_tr_b16 v[202:203], v50 offset:4608
  v_mfma_f32_16x16x32_bf16 v[80:83], v[164:167], v[140:143], v[80:83]
  ds_read_b64_tr_b16 v[204:205], v50 offset:12288
  v_mfma_f32_16x16x32_bf16 v[100:103], v[140:143], v[168:171], v[100:103]
  ds_read_b64_tr_b16 v[206:207], v50 offset:12800
  v_mfma_f32_16x16x32_bf16 v[64:67], v[160:163], v[144:147], v[64:67]
  ds_read_b128 v[172:175], v55 offset:768
  v_mfma_f32_16x16x32_bf16 v[84:87], v[164:167], v[144:147], v[84:87]
  ds_read_b128 v[176:179], v38 offset:49152
  v_mfma_f32_16x16x32_bf16 v[104:107], v[144:147], v[168:171], v[104:107]
  ds_read_b128 v[180:183], v38 offset:51200
  v_mfma_f32_16x16x32_bf16 v[68:71], v[160:163], v[148:151], v[68:71]
  ds_read_b128 v[184:187], v38 offset:53248
  v_mfma_f32_16x16x32_bf16 v[88:91], v[164:167], v[148:151], v[88:91]
  ds_read_b128 v[188:191], v38 offset:55296
  v_mfma_f32_16x16x32_bf16 v[108:111], v[148:151], v[168:171], v[108:111]
  ds_read_b128 v[192:195], v40 offset:49152
  v_mfma_f32_16x16x32_bf16 v[72:75], v[160:163], v[152:155], v[72:75]
  v_mfma_f32_16x16x32_bf16 v[92:95], v[164:167], v[152:155], v[92:95]
  v_mfma_f32_16x16x32_bf16 v[112:115], v[152:155], v[168:171], v[112:115]
  v_mfma_f32_16x16x32_bf16 v[124:127], v[24:27], v[136:139], v[124:127]
  v_mfma_f32_16x16x32_bf16 v[128:131], v[136:139], v[136:139], v[128:131]
  v_mfma_f32_16x16x32_bf16 v[116:119], v[24:27], v[156:159], v[116:119]
  v_mfma_f32_16x16x32_bf16 v[120:123], v[156:159], v[156:159], v[120:123]
  s_waitcnt lgkmcnt(0)
  v_mfma_f32_16x16x32_bf16 v[56:59], v[196:199], v[172:175], v[56:59]
  v_mfma_f32_16x16x32_bf16 v[76:79], v[200:203], v[172:175], v[76:79]
  v_mfma_f32_16x16x32_bf16 v[96:99], v[172:175], v[204:207], v[96:99]
  v_mfma_f32_16x16x32_bf16 v[60:63], v[196:199], v[176:179], v[60:63]
  v_mfma_f32_16x16x32_bf16 v[80:83], v[200:203], v[176:179], v[80:83]
  v_mfma_f32_16x16x32_bf16 v[100:103], v[176:179], v[204:207], v[100:103]
  v_mfma_f32_16x16x32_bf16 v[64:67], v[196:199], v[180:183], v[64:67]
  v_mfma_f32_16x16x32_bf16 v[84:87], v[200:203], v[180:183], v[84:87]
  v_mfma_f32_16x16x32_bf16 v[104:107], v[180:183], v[204:207], v[104:107]
  v_mfma_f32_16x16x32_bf16 v[68:71], v[196:199], v[184:187], v[68:71]
  v_mfma_f32_16x16x32_bf16 v[88:91], v[200:203], v[184:187], v[88:91]
  v_mfma_f32_16x16x32_bf16 v[108:111], v[184:187], v[204:207], v[108:111]
  v_mfma_f32_16x16x32_bf16 v[72:75], v[196:199], v[188:191], v[72:75]
  v_mfma_f32_16x16x32_bf16 v[92:95], v[200:203], v[188:191], v[92:95]
  v_mfma_f32_16x16x32_bf16 v[112:115], v[188:191], v[204:207], v[112:115]
  v_mfma_f32_16x16x32_bf16 v[124:127], v[24:27], v[172:175], v[124:127]
  v_mfma_f32_16x16x32_bf16 v[128:131], v[172:175], v[172:175], v[128:131]
  v_mfma_f32_16x16x32_bf16 v[116:119], v[24:27], v[192:195], v[116:119]
  v_mfma_f32_16x16x32_bf16 v[120:123], v[192:195], v[192:195], v[120:123]
  s_nop 7
  v_cndmask_b32 v133, v120, v121, s[44:45]
  v_cndmask_b32 v133, v133, v122, s[46:47]
  v_cndmask_b32 v133, v133, v123, s[48:49]
  v_mul_f32 v134, 0x3b000000, v116
  v_mul_f32 v135, 0x3b000000, v133
  v_fma_f32 v135, -v134, v134, v135
  v_max_f32 v135, 0, v135
  v_cvt_pk_bf16_f32 v142, v134, v134
  v_lshlrev_b32 v142, 16, v142
  v_cvt_pk_bf16_f32 v135, v135, v135
  v_lshlrev_b32 v135, 16, v135
  v_add_f32 v135, 0x3727c5ac, v135
  v_cvt_pk_bf16_f32 v135, v135, v135
  v_lshlrev_b32 v135, 16, v135
  v_sqrt_f32 v135, v135
  s_nop 0
  v_cvt_pk_bf16_f32 v135, v135, v135
  v_lshlrev_b32 v135, 16, v135
  v_rcp_f32 v143, v135
  v_cndmask_b32 v133, v128, v129, s[44:45]
  v_cndmask_b32 v133, v133, v130, s[46:47]
  v_cndmask_b32 v133, v133, v131, s[48:49]
  v_mul_f32 v134, 0x3b000000, v124
  v_mul_f32 v135, 0x3b000000, v133
  v_fma_f32 v135, -v134, v134, v135
  v_max_f32 v135, 0, v135
  v_cvt_pk_bf16_f32 v144, v134, v134
  v_lshlrev_b32 v144, 16, v144
  v_cvt_pk_bf16_f32 v135, v135, v135
  v_lshlrev_b32 v135, 16, v135
  v_add_f32 v135, 0x3727c5ac, v135
  v_cvt_pk_bf16_f32 v135, v135, v135
  v_lshlrev_b32 v135, 16, v135
  v_sqrt_f32 v135, v135
  s_nop 0
  v_cvt_pk_bf16_f32 v135, v135, v135
  v_lshlrev_b32 v135, 16, v135
  v_rcp_f32 v145, v135
  v_lshlrev_b32 v146, 3, v3
  v_add_u32 v146, 161792, v146
  s_lshl_b32 s53, s4, 7
  v_add_u32 v133, s53, v146
  s_mov_b64 exec, s[50:51]
  ds_write_b64 v133, v[142:143] offset:128
  ds_write_b64 v146, v[144:145]
  s_mov_b64 exec, -1
  s_waitcnt lgkmcnt(0)
  s_barrier
  v_lshlrev_b32 v200, 5, v4
  v_add_u32 v200, 161792, v200
  v_mov_b32 v140, 162688
  ds_read_b32 v140, v140
  ds_read_b64 v[148:149], v146 offset:0
  ds_read_b64 v[150:151], v146 offset:128
  ds_read_b64 v[152:153], v146 offset:256
  ds_read_b64 v[154:155], v146 offset:384
  ds_read_b64 v[156:157], v146 offset:512
  ds_read_b128 v[160:163], v200 offset:0
  ds_read_b128 v[164:167], v200 offset:16
  ds_read_b128 v[168:171], v200 offset:128
  ds_read_b128 v[172:175], v200 offset:144
  ds_read_b128 v[176:179], v200 offset:256
  ds_read_b128 v[180:183], v200 offset:272
  ds_read_b128 v[184:187], v200 offset:384
  ds_read_b128 v[188:191], v200 offset:400
  ds_read_b128 v[192:195], v200 offset:512
  ds_read_b128 v[196:199], v200 offset:528
  v_lshlrev_b32 v133, 2, v3
  ds_bpermute_b32 v212, v133, v96
  v_mov_b32_dpp v204, v56 row_newbcast:0 row_mask:0xf bank_mask:0xf
  v_mov_b32_dpp v208, v76 row_newbcast:0 row_mask:0xf bank_mask:0xf
  v_mov_b32_dpp v205, v57 row_newbcast:0 row_mask:0xf bank_mask:0xf
  v_mov_b32_dpp v209, v77 row_newbcast:0 row_mask:0xf bank_mask:0xf
  v_mov_b32_dpp v206, v58 row_newbcast:0 row_mask:0xf bank_mask:0xf
  v_mov_b32_dpp v210, v78 row_newbcast:0 row_mask:0xf bank_mask:0xf
  v_mov_b32_dpp v207, v59 row_newbcast:0 row_mask:0xf bank_mask:0xf
  v_mov_b32_dpp v211, v79 row_newbcast:0 row_mask:0xf bank_mask:0xf
  s_waitcnt lgkmcnt(0)
  v_readfirstlane_b32 s58, v140
  s_nop 0
  s_cmp_lg_u32 s58, 0
  s_cbranch_scc1 L_FIX
  v_pk_fma_f32 v[76:77], v[148:149], v[208:209], v[76:77] op_sel_hi:[0,1,1] neg_lo:[1,0,0] neg_hi:[1,0,0]
  v_pk_fma_f32 v[78:79], v[148:149], v[210:211], v[78:79] op_sel_hi:[0,1,1] neg_lo:[1,0,0] neg_hi:[1,0,0]
  v_pk_mul_f32 v[76:77], v[148:149], v[76:77] op_sel:[1,0] op_sel_hi:[1,1]
  v_pk_mul_f32 v[78:79], v[148:149], v[78:79] op_sel:[1,0] op_sel_hi:[1,1]
  v_cvt_pk_bf16_f32 v222, v76, v77
  v_cvt_pk_bf16_f32 v223, v78, v79
  v_pk_fma_f32 v[80:81], v[150:151], v[208:209], v[80:81] op_sel_hi:[0,1,1] neg_lo:[1,0,0] neg_hi:[1,0,0]
  v_pk_fma_f32 v[82:83], v[150:151], v[210:211], v[82:83] op_sel_hi:[0,1,1] neg_lo:[1,0,0] neg_hi:[1,0,0]
  v_pk_mul_f32 v[80:81], v[150:151], v[80:81] op_sel:[1,0] op_sel_hi:[1,1]
  v_pk_mul_f32 v[82:83], v[150:151], v[82:83] op_sel:[1,0] op_sel_hi:[1,1]
  v_cvt_pk_bf16_f32 v224, v80, v81
  v_cvt_pk_bf16_f32 v225, v82, v83
  v_pk_fma_f32 v[84:85], v[152:153], v[208:209], v[84:85] op_sel_hi:[0,1,1] neg_lo:[1,0,0] neg_hi:[1,0,0]
  v_pk_fma_f32 v[86:87], v[152:153], v[210:211], v[86:87] op_sel_hi:[0,1,1] neg_lo:[1,0,0] neg_hi:[1,0,0]
  v_pk_mul_f32 v[84:85], v[152:153], v[84:85] op_sel:[1,0] op_sel_hi:[1,1]
  v_pk_mul_f32 v[86:87], v[152:153], v[86:87] op_sel:[1,0] op_sel_hi:[1,1]
  v_cvt_pk_bf16_f32 v226, v84, v85
  v_cvt_pk_bf16_f32 v227, v86, v87
  v_pk_fma_f32 v[88:89], v[154:155], v[208:209], v[88:89] op_sel_hi:[0,1,1] neg_lo:[1,0,0] neg_hi:[1,0,0]
  v_pk_fma_f32 v[90:91], v[154:155], v[210:211], v[90:91] op_sel_hi:[0,1,1] neg_lo:[1,0,0] neg_hi:[1,0,0]
  v_pk_mul_f32 v[88:89], v[154:155], v[88:89] op_sel:[1,0] op_sel_hi:[1,1]
  v_pk_mul_f32 v[90:91], v[154:155], v[90:91] op_sel:[1,0] op_sel_hi:[1,1]
  v_cvt_pk_bf16_f32 v228, v88, v89
  v_cvt_pk_bf16_f32 v229, v90, v91
  v_pk_fma_f32 v[92:93], v[156:157], v[208:209], v[92:93] op_sel_hi:[0,1,1] neg_lo:[1,0,0] neg_hi:[1,0,0]
  v_pk_fma_f32 v[94:95], v[156:157], v[210:211], v[94:95] op_sel_hi:[0,1,1] neg_lo:[1,0,0] neg_hi:[1,0,0]
  v_pk_mul_f32 v[92:93], v[156:157], v[92:93] op_sel:[1,0] op_sel_hi:[1,1]
  v_pk_mul_f32 v[94:95], v[156:157], v[94:95] op_sel:[1,0] op_sel_hi:[1,1]
  v_cvt_pk_bf16_f32 v230, v92, v93
  v_cvt_pk_bf16_f32 v231, v94, v95
  v_pk_fma_f32 v[60:61], v[150:151], v[204:205], v[60:61] op_sel_hi:[0,1,1] neg_lo:[1,0,0] neg_hi:[1,0,0]
  v_pk_fma_f32 v[62:63], v[150:151], v[206:207], v[62:63] op_sel_hi:[0,1,1] neg_lo:[1,0,0] neg_hi:[1,0,0]
  v_pk_mul_f32 v[60:61], v[150:151], v[60:61] op_sel:[1,0] op_sel_hi:[1,1]
  v_pk_mul_f32 v[62:63], v[150:151], v[62:63] op_sel:[1,0] op_sel_hi:[1,1]
  v_cvt_pk_bf16_f32 v214, v60, v61
  v_cvt_pk_bf16_f32 v215, v62, v63
  v_pk_fma_f32 v[64:65], v[152:153], v[204:205], v[64:65] op_sel_hi:[0,1,1] neg_lo:[1,0,0] neg_hi:[1,0,0]
  v_pk_fma_f32 v[66:67], v[152:153], v[206:207], v[66:67] op_sel_hi:[0,1,1] neg_lo:[1,0,0] neg_hi:[1,0,0]
  v_pk_mul_f32 v[64:65], v[152:153], v[64:65] op_sel:[1,0] op_sel_hi:[1,1]
  v_pk_mul_f32 v[66:67], v[152:153], v[66:67] op_sel:[1,0] op_sel_hi:[1,1]
  v_cvt_pk_bf16_f32 v216, v64, v65
  v_cvt_pk_bf16_f32 v217, v66, v67
  v_pk_fma_f32 v[68:69], v[154:155], v[204:205], v[68:69] op_sel_hi:[0,1,1] neg_lo:[1,0,0] neg_hi:[1,0,0]
  v_pk_fma_f32 v[70:71], v[154:155], v[206:207], v[70:71] op_sel_hi:[0,1,1] neg_lo:[1,0,0] neg_hi:[1,0,0]
  v_pk_mul_f32 v[68:69], v[154:155], v[68:69] op_sel:[1,0] op_sel_hi:[1,1]
  v_pk_mul_f32 v[70:71], v[154:155], v[70:71] op_sel:[1,0] op_sel_hi:[1,1]
  v_cvt_pk_bf16_f32 v218, v68, v69
  v_cvt_pk_bf16_f32 v219, v70, v71
  v_pk_fma_f32 v[72:73], v[156:157], v[204:205], v[72:73] op_sel_hi:[0,1,1] neg_lo:[1,0,0] neg_hi:[1,0,0]
  v_pk_fma_f32 v[74:75], v[156:157], v[206:207], v[74:75] op_sel_hi:[0,1,1] neg_lo:[1,0,0] neg_hi:[1,0,0]
  v_pk_mul_f32 v[72:73], v[156:157], v[72:73] op_sel:[1,0] op_sel_hi:[1,1]
  v_pk_mul_f32 v[74:75], v[156:157], v[74:75] op_sel:[1,0] op_sel_hi:[1,1]
  v_cvt_pk_bf16_f32 v220, v72, v73
  v_cvt_pk_bf16_f32 v221, v74, v75
  v_mfma_f32_16x16x16_bf16 v[60:63], v[222:223], v[214:215], 0
  v_mfma_f32_16x16x16_bf16 v[80:83], v[224:225], v[214:215], 0
  v_mfma_f32_16x16x16_bf16 v[64:67], v[222:223], v[216:217], 0
  v_mfma_f32_16x16x16_bf16 v[84:87], v[226:227], v[216:217], 0
  v_mfma_f32_16x16x16_bf16 v[68:71], v[224:225], v[218:219], 0
  v_mfma_f32_16x16x16_bf16 v[88:91], v[228:229], v[218:219], 0
  v_mfma_f32_16x16x16_bf16 v[72:75], v[226:227], v[220:221], 0
  v_mfma_f32_16x16x16_bf16 v[92:95], v[230:231], v[220:221], 0
  v_fma_f32 v96, -v160, v212, v96
  v_fma_f32 v97, -v162, v212, v97
  v_fma_f32 v98, -v164, v212, v98
  v_fma_f32 v99, -v166, v212, v99
  v_mul_f32 v96, v161, v96
  v_mul_f32 v97, v163, v97
  v_mul_f32 v98, v165, v98
  v_mul_f32 v99, v167, v99
  v_cvt_pk_bf16_f32 v232, v96, v97
  v_cvt_pk_bf16_f32 v233, v98, v99
  v_fma_f32 v100, -v168, v212, v100
  v_fma_f32 v101, -v170, v212, v101
  v_fma_f32 v102, -v172, v212, v102
  v_fma_f32 v103, -v174, v212, v103
  v_mul_f32 v100, v169, v100
  v_mul_f32 v101, v171, v101
  v_mul_f32 v102, v173, v102
  v_mul_f32 v103, v175, v103
  v_cvt_pk_bf16_f32 v234, v100, v101
  v_cvt_pk_bf16_f32 v235, v102, v103
  v_fma_f32 v104, -v176, v212, v104
  v_fma_f32 v105, -v178, v212, v105
  v_fma_f32 v106, -v180, v212, v106
  v_fma_f32 v107, -v182, v212, v107
  v_mul_f32 v104, v177, v104
  v_mul_f32 v105, v179, v105
  v_mul_f32 v106, v181, v106
  v_mul_f32 v107, v183, v107
  v_cvt_pk_bf16_f32 v240, v104, v105
  v_cvt_pk_bf16_f32 v241, v106, v107
  v_fma_f32 v108, -v184, v212, v108
  v_fma_f32 v109, -v186, v212, v109
  v_fma_f32 v110, -v188, v212, v110
  v_fma_f32 v111, -v190, v212, v111
  v_mul_f32 v108, v185, v108
  v_mul_f32 v109, v187, v109
  v_mul_f32 v110, v189, v110
  v_mul_f32 v111, v191, v111
  v_cvt_pk_bf16_f32 v236, v108, v109
  v_cvt_pk_bf16_f32 v237, v110, v111
  v_fma_f32 v112, -v192, v212, v112
  v_fma_f32 v113, -v194, v212, v113
  v_fma_f32 v114, -v196, v212, v114
  v_fma_f32 v115, -v198, v212, v115
  v_mul_f32 v112, v193, v112
  v_mul_f32 v113, v195, v113
  v_mul_f32 v114, v197, v114
  v_mul_f32 v115, v199, v115
  v_cvt_pk_bf16_f32 v242, v112, v113
  v_cvt_pk_bf16_f32 v243, v114, v115
  v_mov_b32 v238, v232
  v_mov_b32 v239, v233
  v_mov_b32 v244, 0xff800000
  v_cvt_pk_bf16_f32 v100, v60, v61
  v_cvt_pk_bf16_f32 v101, v62, v63
  v_cvt_pk_bf16_f32 v102, v80, v81
  v_cvt_pk_bf16_f32 v103, v82, v83
  v_cvt_pk_bf16_f32 v104, v64, v65
  v_cvt_pk_bf16_f32 v105, v66, v67
  v_cvt_pk_bf16_f32 v106, v84, v85
  v_cvt_pk_bf16_f32 v107, v86, v87
  v_cvt_pk_bf16_f32 v108, v68, v69
  v_cvt_pk_bf16_f32 v109, v70, v71
  v_cvt_pk_bf16_f32 v110, v88, v89
  v_cvt_pk_bf16_f32 v111, v90, v91
  v_cvt_pk_bf16_f32 v112, v72, v73
  v_cvt_pk_bf16_f32 v113, v74, v75
  v_cvt_pk_bf16_f32 v114, v92, v93
  v_cvt_pk_bf16_f32 v115, v94, v95
  v_lshlrev_b32 v60, 16, v100
  v_and_b32 v61, 0xffff0000, v100
  v_lshlrev_b32 v62, 16, v101
  v_and_b32 v63, 0xffff0000, v101
  v_lshlrev_b32 v80, 16, v102
  v_and_b32 v81, 0xffff0000, v102
  v_lshlrev_b32 v82, 16, v103
  v_and_b32 v83, 0xffff0000, v103
  v_lshlrev_b32 v64, 16, v104
  v_and_b32 v65, 0xffff0000, v104
  v_lshlrev_b32 v66, 16, v105
  v_and_b32 v67, 0xffff0000, v105
  v_lshlrev_b32 v84, 16, v106
  v_and_b32 v85, 0xffff0000, v106
  v_lshlrev_b32 v86, 16, v107
  v_and_b32 v87, 0xffff0000, v107
  v_lshlrev_b32 v68, 16, v108
  v_and_b32 v69, 0xffff0000, v108
  v_lshlrev_b32 v70, 16, v109
  v_and_b32 v71, 0xffff0000, v109
  v_lshlrev_b32 v88, 16, v110
  v_and_b32 v89, 0xffff0000, v110
  v_lshlrev_b32 v90, 16, v111
  v_and_b32 v91, 0xffff0000, v111
  v_lshlrev_b32 v72, 16, v112
  v_and_b32 v73, 0xffff0000, v112
  v_lshlrev_b32 v74, 16, v113
  v_and_b32 v75, 0xffff0000, v113
  v_lshlrev_b32 v92, 16, v114
  v_and_b32 v93, 0xffff0000, v114
  v_lshlrev_b32 v94, 16, v115
  v_and_b32 v95, 0xffff0000, v115
  v_cndmask_b32 v60, v244, v60, s[76:77]
  v_cndmask_b32 v80, v244, v80, s[60:61]
  v_cndmask_b32 v61, v244, v61, s[78:79]
  v_cndmask_b32 v81, v244, v81, s[62:63]
  v_cndmask_b32 v62, v244, v62, s[80:81]
  v_cndmask_b32 v82, v244, v82, s[64:65]
  v_cndmask_b32 v63, v244, v63, s[82:83]
  v_cndmask_b32 v83, v244, v83, s[66:67]
  v_cndmask_b32 v64, v244, v64, s[84:85]
  v_cndmask_b32 v84, v244, v84, s[60:61]
  v_cndmask_b32 v65, v244, v65, s[86:87]
  v_cndmask_b32 v85, v244, v85, s[62:63]
  v_cndmask_b32 v66, v244, v66, s[88:89]
  v_cndmask_b32 v86, v244, v86, s[64:65]
  v_cndmask_b32 v67, v244, v67, s[90:91]
  v_cndmask_b32 v87, v244, v87, s[66:67]
  v_cndmask_b32 v68, v244, v68, s[68:69]
  v_cndmask_b32 v88, v244, v88, s[60:61]
  v_cndmask_b32 v69, v244, v69, s[70:71]
  v_cndmask_b32 v89, v244, v89, s[62:63]
  v_cndmask_b32 v70, v244, v70, s[72:73]
  v_cndmask_b32 v90, v244, v90, s[64:65]
  v_cndmask_b32 v71, v244, v71, s[74:75]
  v_cndmask_b32 v91, v244, v91, s[66:67]
  v_cndmask_b32 v72, v244, v72, s[68:69]
  v_cndmask_b32 v92, v244, v92, s[60:61]
  v_cndmask_b32 v73, v244, v73, s[70:71]
  v_cndmask_b32 v93, v244, v93, s[62:63]
  v_cndmask_b32 v74, v244, v74, s[72:73]
  v_cndmask_b32 v94, v244, v94, s[64:65]
  v_cndmask_b32 v75, v244, v75, s[74:75]
  v_cndmask_b32 v95, v244, v95, s[66:67]
  v_max3_f32 v246, v60, v61, v62
  v_max3_f32 v247, v63, v80, v81
  v_max3_f32 v246, v246, v82, v83
  v_max_f32 v246, v246, v247
  v_max3_f32 v248, v64, v65, v66
  v_max3_f32 v249, v67, v84, v85
  v_max3_f32 v248, v248, v86, v87
  v_max_f32 v248, v248, v249
  v_max3_f32 v250, v68, v69, v70
  v_max3_f32 v251, v71, v88, v89
  v_max3_f32 v250, v250, v90, v91
  v_max_f32 v250, v250, v251
  v_max3_f32 v252, v72, v73, v74
  v_max3_f32 v253, v75, v92, v93
  v_max3_f32 v252, v252, v94, v95
  v_max_f32 v252, v252, v253
  v_mov_b32 v247, v246
  v_mov_b32 v249, v248
  v_mov_b32 v251, v250
  v_mov_b32 v253, v252
  v_permlane16_swap_b32 v246, v247
  v_permlane16_swap_b32 v248, v249
  v_permlane16_swap_b32 v250, v251
  v_permlane16_swap_b32 v252, v253
  v_max_f32 v246, v246, v247
  v_max_f32 v248, v248, v249
  v_max_f32 v250, v250, v251
  v_max_f32 v252, v252, v253
  v_mov_b32 v247, v246
  v_mov_b32 v249, v248
  v_mov_b32 v251, v250
  v_mov_b32 v253, v252
  v_permlane32_swap_b32 v246, v247
  v_permlane32_swap_b32 v248, v249
  v_permlane32_swap_b32 v250, v251
  v_permlane32_swap_b32 v252, v253
  v_max_f32 v246, v246, v247
  v_max_f32 v248, v248, v249
  v_max_f32 v250, v250, v251
  v_max_f32 v252, v252, v253
  v_mul_f32 v246, 0x3eb8aa3b, v246
  v_mul_f32 v248, 0x3eb8aa3b, v248
  v_mul_f32 v250, 0x3eb8aa3b, v250
  v_mul_f32 v252, 0x3eb8aa3b, v252
  v_mov_b32 v247, 0x3eb8aa3b
  v_mov_b32 v249, 0x3eb8aa3b
  v_mov_b32 v251, 0x3eb8aa3b
  v_mov_b32 v253, 0x3eb8aa3b
  v_pk_fma_f32 v[60:61], v[60:61], v[246:247], v[246:247] op_sel:[0,1,0] op_sel_hi:[1,1,0] neg_lo:[0,0,1] neg_hi:[0,0,1]
  v_pk_fma_f32 v[62:63], v[62:63], v[246:247], v[246:247] op_sel:[0,1,0] op_sel_hi:[1,1,0] neg_lo:[0,0,1] neg_hi:[0,0,1]
  v_pk_fma_f32 v[80:81], v[80:81], v[246:247], v[246:247] op_sel:[0,1,0] op_sel_hi:[1,1,0] neg_lo:[0,0,1] neg_hi:[0,0,1]
  v_pk_fma_f32 v[82:83], v[82:83], v[246:247], v[246:247] op_sel:[0,1,0] op_sel_hi:[1,1,0] neg_lo:[0,0,1] neg_hi:[0,0,1]
  v_pk_fma_f32 v[64:65], v[64:65], v[248:249], v[248:249] op_sel:[0,1,0] op_sel_hi:[1,1,0] neg_lo:[0,0,1] neg_hi:[0,0,1]
  v_pk_fma_f32 v[66:67], v[66:67], v[248:249], v[248:249] op_sel:[0,1,0] op_sel_hi:[1,1,0] neg_lo:[0,0,1] neg_hi:[0,0,1]
  v_pk_fma_f32 v[84:85], v[84:85], v[248:249], v[248:249] op_sel:[0,1,0] op_sel_hi:[1,1,0] neg_lo:[0,0,1] neg_hi:[0,0,1]
  v_pk_fma_f32 v[86:87], v[86:87], v[248:249], v[248:249] op_sel:[0,1,0] op_sel_hi:[1,1,0] neg_lo:[0,0,1] neg_hi:[0,0,1]
  v_pk_fma_f32 v[68:69], v[68:69], v[250:251], v[250:251] op_sel:[0,1,0] op_sel_hi:[1,1,0] neg_lo:[0,0,1] neg_hi:[0,0,1]
  v_pk_fma_f32 v[70:71], v[70:71], v[250:251], v[250:251] op_sel:[0,1,0] op_sel_hi:[1,1,0] neg_lo:[0,0,1] neg_hi:[0,0,1]
  v_pk_fma_f32 v[88:89], v[88:89], v[250:251], v[250:251] op_sel:[0,1,0] op_sel_hi:[1,1,0] neg_lo:[0,0,1] neg_hi:[0,0,1]
  v_pk_fma_f32 v[90:91], v[90:91], v[250:251], v[250:251] op_sel:[0,1,0] op_sel_hi:[1,1,0] neg_lo:[0,0,1] neg_hi:[0,0,1]
  v_pk_fma_f32 v[72:73], v[72:73], v[252:253], v[252:253] op_sel:[0,1,0] op_sel_hi:[1,1,0] neg_lo:[0,0,1] neg_hi:[0,0,1]
  v_pk_fma_f32 v[74:75], v[74:75], v[252:253], v[252:253] op_sel:[0,1,0] op_sel_hi:[1,1,0] neg_lo:[0,0,1] neg_hi:[0,0,1]
  v_pk_fma_f32 v[92:93], v[92:93], v[252:253], v[252:253] op_sel:[0,1,0] op_sel_hi:[1,1,0] neg_lo:[0,0,1] neg_hi:[0,0,1]
  v_pk_fma_f32 v[94:95], v[94:95], v[252:253], v[252:253] op_sel:[0,1,0] op_sel_hi:[1,1,0] neg_lo:[0,0,1] neg_hi:[0,0,1]
  v_exp_f32 v60, v60
  v_exp_f32 v61, v61
  v_exp_f32 v62, v62
  v_exp_f32 v63, v63
  v_exp_f32 v80, v80
  v_exp_f32 v81, v81
  v_exp_f32 v82, v82
  v_exp_f32 v83, v83
  v_exp_f32 v64, v64
  v_exp_f32 v65, v65
  v_exp_f32 v66, v66
  v_exp_f32 v67, v67
  v_exp_f32 v84, v84
  v_exp_f32 v85, v85
  v_exp_f32 v86, v86
  v_exp_f32 v87, v87
  v_exp_f32 v68, v68
  v_exp_f32 v69, v69
  v_exp_f32 v70, v70
  v_exp_f32 v71, v71
  v_exp_f32 v88, v88
  v_exp_f32 v89, v89
  v_exp_f32 v90, v90
  v_exp_f32 v91, v91
  v_exp_f32 v72, v72
  v_exp_f32 v73, v73
  v_exp_f32 v74, v74
  v_exp_f32 v75, v75
  v_exp_f32 v92, v92
  v_exp_f32 v93, v93
  v_exp_f32 v94, v94
  v_exp_f32 v95, v95
  v_pk_add_f32 v[246:247], v[60:61], v[62:63]
  v_pk_add_f32 v[246:247], v[246:247], v[80:81]
  v_pk_add_f32 v[246:247], v[246:247], v[82:83]
  v_add_f32 v246, v246, v247
  v_pk_add_f32 v[248:249], v[64:65], v[66:67]
  v_pk_add_f32 v[248:249], v[248:249], v[84:85]
  v_pk_add_f32 v[248:249], v[248:249], v[86:87]
  v_add_f32 v248, v248, v249
  v_pk_add_f32 v[250:251], v[68:69], v[70:71]
  v_pk_add_f32 v[250:251], v[250:251], v[88:89]
  v_pk_add_f32 v[250:251], v[250:251], v[90:91]
  v_add_f32 v250, v250, v251
  v_pk_add_f32 v[252:253], v[72:73], v[74:75]
  v_pk_add_f32 v[252:253], v[252:253], v[92:93]
  v_pk_add_f32 v[252:253], v[252:253], v[94:95]
  v_add_f32 v252, v252, v253
  v_mov_b32 v247, v246
  v_mov_b32 v249, v248
  v_mov_b32 v251, v250
  v_mov_b32 v253, v252
  v_permlane16_swap_b32 v246, v247
  v_permlane16_swap_b32 v248, v249
  v_permlane16_swap_b32 v250, v251
  v_permlane16_swap_b32 v252, v253
  v_add_f32 v246, v246, v247
  v_add_f32 v248, v248, v249
  v_add_f32 v250, v250, v251
  v_add_f32 v252, v252, v253
  v_mov_b32 v247, v246
  v_mov_b32 v249, v248
  v_mov_b32 v251, v250
  v_mov_b32 v253, v252
  v_permlane32_swap_b32 v246, v247
  v_permlane32_swap_b32 v248, v249
  v_permlane32_swap_b32 v250, v251
  v_permlane32_swap_b32 v252, v253
  v_add_f32 v246, v246, v247
  v_add_f32 v248, v248, v249
  v_add_f32 v250, v250, v251
  v_add_f32 v252, v252, v253
  v_rcp_f32 v246, v246
  v_rcp_f32 v248, v248
  v_rcp_f32 v250, v250
  v_rcp_f32 v252, v252
  v_pk_mul_f32 v[60:61], v[60:61], v[246:247] op_sel_hi:[1,0]
  v_pk_mul_f32 v[62:63], v[62:63], v[246:247] op_sel_hi:[1,0]
  v_pk_mul_f32 v[80:81], v[80:81], v[246:247] op_sel_hi:[1,0]
  v_pk_mul_f32 v[82:83], v[82:83], v[246:247] op_sel_hi:[1,0]
  v_pk_mul_f32 v[64:65], v[64:65], v[248:249] op_sel_hi:[1,0]
  v_pk_mul_f32 v[66:67], v[66:67], v[248:249] op_sel_hi:[1,0]
  v_pk_mul_f32 v[84:85], v[84:85], v[248:249] op_sel_hi:[1,0]
  v_pk_mul_f32 v[86:87], v[86:87], v[248:249] op_sel_hi:[1,0]
  v_pk_mul_f32 v[68:69], v[68:69], v[250:251] op_sel_hi:[1,0]
  v_pk_mul_f32 v[70:71], v[70:71], v[250:251] op_sel_hi:[1,0]
  v_pk_mul_f32 v[88:89], v[88:89], v[250:251] op_sel_hi:[1,0]
  v_pk_mul_f32 v[90:91], v[90:91], v[250:251] op_sel_hi:[1,0]
  v_pk_mul_f32 v[72:73], v[72:73], v[252:253] op_sel_hi:[1,0]
  v_pk_mul_f32 v[74:75], v[74:75], v[252:253] op_sel_hi:[1,0]
  v_pk_mul_f32 v[92:93], v[92:93], v[252:253] op_sel_hi:[1,0]
  v_pk_mul_f32 v[94:95], v[94:95], v[252:253] op_sel_hi:[1,0]
  v_cvt_pk_bf16_f32 v100, v60, v61
  v_cvt_pk_bf16_f32 v101, v62, v63
  v_cvt_pk_bf16_f32 v102, v80, v81
  v_cvt_pk_bf16_f32 v103, v82, v83
  v_cvt_pk_bf16_f32 v104, v64, v65
  v_cvt_pk_bf16_f32 v105, v66, v67
  v_cvt_pk_bf16_f32 v106, v84, v85
  v_cvt_pk_bf16_f32 v107, v86, v87
  v_cvt_pk_bf16_f32 v108, v68, v69
  v_cvt_pk_bf16_f32 v109, v70, v71
  v_cvt_pk_bf16_f32 v110, v88, v89
  v_cvt_pk_bf16_f32 v111, v90, v91
  v_cvt_pk_bf16_f32 v112, v72, v73
  v_cvt_pk_bf16_f32 v113, v74, v75
  v_cvt_pk_bf16_f32 v114, v92, v93
  v_cvt_pk_bf16_f32 v115, v94, v95
  v_mfma_f32_16x16x32_bf16 v[60:63], v[232:235], v[100:103], 0
  v_mfma_f32_16x16x32_bf16 v[64:67], v[238:241], v[104:107], 0
  v_mfma_f32_16x16x32_bf16 v[68:71], v[234:237], v[108:111], 0
  v_mfma_f32_16x16x32_bf16 v[72:75], v[240:243], v[112:115], 0
  s_lshl_b32 s53, s40, 16
  s_lshl_b32 s54, s41, 11
  s_add_u32 s53, s53, s54
  s_lshr_b32 s54, s4, 1
  s_lshl_b32 s54, s54, 10
  s_add_u32 s53, s53, s54
  s_and_b32 s54, s4, 1
  s_lshl_b32 s54, s54, 3
  s_add_u32 s53, s53, s54
  s_mul_i32 s54, s42, 221184
  s_add_u32 s53, s53, s54
  s_add_u32 s53, s53, 4194304
  v_cvt_pk_bf16_f32 v100, v60, v61
  v_cvt_pk_bf16_f32 v101, v62, v63
  buffer_store_dwordx2 v[100:101], v5, s[36:39], s53 offen
  s_add_u32 s53, s53, 16384
  v_cvt_pk_bf16_f32 v104, v64, v65
  v_cvt_pk_bf16_f32 v105, v66, v67
  buffer_store_dwordx2 v[104:105], v5, s[36:39], s53 offen
  s_add_u32 s53, s53, 16384
  v_cvt_pk_bf16_f32 v108, v68, v69
  v_cvt_pk_bf16_f32 v109, v70, v71
  buffer_store_dwordx2 v[108:109], v5, s[36:39], s53 offen
  s_add_u32 s53, s53, 16384
  v_cvt_pk_bf16_f32 v112, v72, v73
  v_cvt_pk_bf16_f32 v113, v74, v75
  buffer_store_dwordx2 v[112:113], v5, s[36:39], s53 offen
  s_mul_i32 s54, s5, 2048
  s_add_u32 s54, s54, 9961472
  s_lshl_b32 s55, s6, 4
  s_add_u32 s54, s54, s55
  s_lshl_b32 s55, s4, 2
  s_add_u32 s54, s54, s55
  v_mov_b32 v6, 0
  s_waitcnt vmcnt(0)
  s_mov_b64 exec, 1
  buffer_store_dword v36, v6, s[36:39], s54 offen
  s_mov_b64 exec, -1
  v_bfe_u32 v6, v2, 2, 2
  v_lshl_add_u32 v6, v4, 2, v6
  v_bfe_u32 v7, v6, 1, 2
  s_and_b32 s53, s4, 1
  s_lshl_b32 s53, s53, 1
  v_xor_b32 v7, s53, v7
  v_and_b32 v8, 3, v2
  v_lshlrev_b32 v8, 3, v8
  v_lshl_add_u32 v8, v7, 5, v8
  v_lshl_add_u32 v37, v6, 7, v8
  v_xor_b32 v38, 32, v37
  s_lshr_b32 s53, s4, 1
  s_lshl_b32 s53, s53, 11
  v_add_u32 v39, s53, v5
  v_add_u32 v40, 65536, v37
  v_add_u32 v41, 131072, v37
  v_add_u32 v42, 65536, v38
  v_add_u32 v43, 131072, v38
  v_add_u32 v44, 65536, v39
  v_add_u32 v45, 131072, v39
  v_mov_b32 v48, 0
  v_mov_b32 v49, 0
  v_mov_b32 v50, 0
  v_mov_b32 v51, 0
  v_mov_b32 v52, 0
  v_mov_b32 v53, 0
  v_mov_b32 v54, 0
  v_mov_b32 v55, 0
  v_mov_b32 v56, 0
  v_mov_b32 v57, 0
  v_mov_b32 v58, 0
  v_mov_b32 v59, 0
  v_mov_b32 v60, 0
  v_mov_b32 v61, 0
  v_mov_b32 v62, 0
  v_mov_b32 v63, 0
  s_barrier
  ds_read_b64_tr_b16 v[64:65], v41 offset:26624
  ds_read_b64_tr_b16 v[66:67], v41 offset:28672
  ds_read_b64_tr_b16 v[68:69], v43 offset:26624
  ds_read_b64_tr_b16 v[70:71], v43 offset:28672
  ds_read_b128 v[72:75], v39 offset:0
  ds_read_b128 v[76:79], v39 offset:1024
  ds_read_b64_tr_b16 v[80:81], v41 offset:22528
  ds_read_b64_tr_b16 v[82:83], v41 offset:24576
  ds_read_b64_tr_b16 v[84:85], v43 offset:22528
  ds_read_b64_tr_b16 v[86:87], v43 offset:24576
  ds_read_b128 v[88:91], v39 offset:4096
  ds_read_b128 v[92:95], v39 offset:5120
  s_waitcnt lgkmcnt(0)
  v_mfma_f32_16x16x32_bf16 v[48:51], v[64:67], v[72:75], v[48:51]
  s_barrier
  v_mfma_f32_16x16x32_bf16 v[52:55], v[68:71], v[72:75], v[52:55]
  ds_read_b64_tr_b16 v[96:97], v41 offset:18432
  ds_read_b64_tr_b16 v[98:99], v41 offset:20480
  v_mfma_f32_16x16x32_bf16 v[56:59], v[64:67], v[76:79], v[56:59]
  ds_read_b64_tr_b16 v[100:101], v43 offset:18432
  ds_read_b64_tr_b16 v[102:103], v43 offset:20480
  v_mfma_f32_16x16x32_bf16 v[60:63], v[68:71], v[76:79], v[60:63]
  ds_read_b128 v[104:107], v39 offset:8192
  ds_read_b128 v[108:111], v39 offset:9216
  v_mfma_f32_16x16x32_bf16 v[48:51], v[80:83], v[88:91], v[48:51]
  ds_read_b64_tr_b16 v[112:113], v41 offset:14336
  ds_read_b64_tr_b16 v[114:115], v41 offset:16384
  v_mfma_f32_16x16x32_bf16 v[52:55], v[84:87], v[88:91], v[52:55]
  ds_read_b64_tr_b16 v[116:117], v43 offset:14336
  ds_read_b64_tr_b16 v[118:119], v43 offset:16384
  v_mfma_f32_16x16x32_bf16 v[56:59], v[80:83], v[92:95], v[56:59]
  ds_read_b128 v[120:123], v39 offset:12288
  ds_read_b128 v[124:127], v39 offset:13312
  v_mfma_f32_16x16x32_bf16 v[60:63], v[84:87], v[92:95], v[60:63]
  s_waitcnt lgkmcnt(0)
  v_mfma_f32_16x16x32_bf16 v[48:51], v[96:99], v[104:107], v[48:51]
  s_barrier
  v_mfma_f32_16x16x32_bf16 v[52:55], v[100:103], v[104:107], v[52:55]
  ds_read_b64_tr_b16 v[64:65], v41 offset:10240
  ds_read_b64_tr_b16 v[66:67], v41 offset:12288
  v_mfma_f32_16x16x32_bf16 v[56:59], v[96:99], v[108:111], v[56:59]
  ds_read_b64_tr_b16 v[68:69], v43 offset:10240
  ds_read_b64_tr_b16 v[70:71], v43 offset:12288
  v_mfma_f32_16x16x32_bf16 v[60:63], v[100:103], v[108:111], v[60:63]
  ds_read_b128 v[72:75], v39 offset:16384
  ds_read_b128 v[76:79], v39 offset:17408
  v_mfma_f32_16x16x32_bf16 v[48:51], v[112:115], v[120:123], v[48:51]
  ds_read_b64_tr_b16 v[80:81], v41 offset:6144
  ds_read_b64_tr_b16 v[82:83], v41 offset:8192
  v_mfma_f32_16x16x32_bf16 v[52:55], v[116:119], v[120:123], v[52:55]
  ds_read_b64_tr_b16 v[84:85], v43 offset:6144
  ds_read_b64_tr_b16 v[86:87], v43 offset:8192
  v_mfma_f32_16x16x32_bf16 v[56:59], v[112:115], v[124:127], v[56:59]
  ds_read_b128 v[88:91], v39 offset:20480
  ds_read_b128 v[92:95], v39 offset:21504
  v_mfma_f32_16x16x32_bf16 v[60:63], v[116:119], v[124:127], v[60:63]
  s_waitcnt lgkmcnt(0)
  v_mfma_f32_16x16x32_bf16 v[48:51], v[64:67], v[72:75], v[48:51]
  ds_read_b64_tr_b16 v[96:97], v41 offset:2048
  ds_read_b64_tr_b16 v[98:99], v41 offset:4096
  v_mfma_f32_16x16x32_bf16 v[52:55], v[68:71], v[72:75], v[52:55]
  ds_read_b64_tr_b16 v[100:101], v43 offset:2048
  ds_read_b64_tr_b16 v[102:103], v43 offset:4096
  v_mfma_f32_16x16x32_bf16 v[56:59], v[64:67], v[76:79], v[56:59]
  ds_read_b128 v[104:107], v39 offset:24576
  ds_read_b128 v[108:111], v39 offset:25600
  v_mfma_f32_16x16x32_bf16 v[60:63], v[68:71], v[76:79], v[60:63]
  ds_read_b64_tr_b16 v[112:113], v40 offset:63488
  ds_read_b64_tr_b16 v[114:115], v41 offset:0
  v_mfma_f32_16x16x32_bf16 v[48:51], v[80:83], v[88:91], v[48:51]
  ds_read_b64_tr_b16 v[116:117], v42 offset:63488
  ds_read_b64_tr_b16 v[118:119], v43 offset:0
  v_mfma_f32_16x16x32_bf16 v[52:55], v[84:87], v[88:91], v[52:55]
  ds_read_b128 v[120:123], v39 offset:28672
  ds_read_b128 v[124:127], v39 offset:29696
  v_mfma_f32_16x16x32_bf16 v[56:59], v[80:83], v[92:95], v[56:59]
  v_mfma_f32_16x16x32_bf16 v[60:63], v[84:87], v[92:95], v[60:63]
  s_waitcnt lgkmcnt(0)
  v_mfma_f32_16x16x32_bf16 v[48:51], v[96:99], v[104:107], v[48:51]
  s_barrier
  v_mfma_f32_16x16x32_bf16 v[52:55], v[100:103], v[104:107], v[52:55]
  ds_read_b64_tr_b16 v[64:65], v40 offset:59392
  ds_read_b64_tr_b16 v[66:67], v40 offset:61440
  v_mfma_f32_16x16x32_bf16 v[56:59], v[96:99], v[108:111], v[56:59]
  ds_read_b64_tr_b16 v[68:69], v42 offset:59392
  ds_read_b64_tr_b16 v[70:71], v42 offset:61440
  v_mfma_f32_16x16x32_bf16 v[60:63], v[100:103], v[108:111], v[60:63]
  ds_read_b128 v[72:75], v39 offset:32768
  ds_read_b128 v[76:79], v39 offset:33792
  v_mfma_f32_16x16x32_bf16 v[48:51], v[112:115], v[120:123], v[48:51]
  ds_read_b64_tr_b16 v[80:81], v40 offset:55296
  ds_read_b64_tr_b16 v[82:83], v40 offset:57344
  v_mfma_f32_16x16x32_bf16 v[52:55], v[116:119], v[120:123], v[52:55]
  ds_read_b64_tr_b16 v[84:85], v42 offset:55296
  ds_read_b64_tr_b16 v[86:87], v42 offset:57344
  v_mfma_f32_16x16x32_bf16 v[56:59], v[112:115], v[124:127], v[56:59]
  ds_read_b128 v[88:91], v39 offset:36864
  ds_read_b128 v[92:95], v39 offset:37888
  v_mfma_f32_16x16x32_bf16 v[60:63], v[116:119], v[124:127], v[60:63]
  s_waitcnt lgkmcnt(0)
  v_mfma_f32_16x16x32_bf16 v[48:51], v[64:67], v[72:75], v[48:51]
  ds_read_b64_tr_b16 v[96:97], v40 offset:51200
  ds_read_b64_tr_b16 v[98:99], v40 offset:53248
  v_mfma_f32_16x16x32_bf16 v[52:55], v[68:71], v[72:75], v[52:55]
  ds_read_b64_tr_b16 v[100:101], v42 offset:51200
  ds_read_b64_tr_b16 v[102:103], v42 offset:53248
  v_mfma_f32_16x16x32_bf16 v[56:59], v[64:67], v[76:79], v[56:59]
  ds_read_b128 v[104:107], v39 offset:40960
  ds_read_b128 v[108:111], v39 offset:41984
  v_mfma_f32_16x16x32_bf16 v[60:63], v[68:71], v[76:79], v[60:63]
  ds_read_b64_tr_b16 v[112:113], v40 offset:47104
  ds_read_b64_tr_b16 v[114:115], v40 offset:49152
  v_mfma_f32_16x16x32_bf16 v[48:51], v[80:83], v[88:91], v[48:51]
  ds_read_b64_tr_b16 v[116:117], v42 offset:47104
  ds_read_b64_tr_b16 v[118:119], v42 offset:49152
  v_mfma_f32_16x16x32_bf16 v[52:55], v[84:87], v[88:91], v[52:55]
  ds_read_b128 v[120:123], v39 offset:45056
  ds_read_b128 v[124:127], v39 offset:46080
  v_mfma_f32_16x16x32_bf16 v[56:59], v[80:83], v[92:95], v[56:59]
  v_mfma_f32_16x16x32_bf16 v[60:63], v[84:87], v[92:95], v[60:63]
  s_waitcnt lgkmcnt(0)
  v_mfma_f32_16x16x32_bf16 v[48:51], v[96:99], v[104:107], v[48:51]
  s_barrier
  v_mfma_f32_16x16x32_bf16 v[52:55], v[100:103], v[104:107], v[52:55]
  ds_read_b64_tr_b16 v[64:65], v40 offset:43008
  ds_read_b64_tr_b16 v[66:67], v40 offset:45056
  v_mfma_f32_16x16x32_bf16 v[56:59], v[96:99], v[108:111], v[56:59]
  ds_read_b64_tr_b16 v[68:69], v42 offset:43008
  ds_read_b64_tr_b16 v[70:71], v42 offset:45056
  v_mfma_f32_16x16x32_bf16 v[60:63], v[100:103], v[108:111], v[60:63]
  ds_read_b128 v[72:75], v39 offset:49152
  ds_read_b128 v[76:79], v39 offset:50176
  v_mfma_f32_16x16x32_bf16 v[48:51], v[112:115], v[120:123], v[48:51]
  ds_read_b64_tr_b16 v[80:81], v40 offset:38912
  ds_read_b64_tr_b16 v[82:83], v40 offset:40960
  v_mfma_f32_16x16x32_bf16 v[52:55], v[116:119], v[120:123], v[52:55]
  ds_read_b64_tr_b16 v[84:85], v42 offset:38912
  ds_read_b64_tr_b16 v[86:87], v42 offset:40960
  v_mfma_f32_16x16x32_bf16 v[56:59], v[112:115], v[124:127], v[56:59]
  ds_read_b128 v[88:91], v39 offset:53248
  ds_read_b128 v[92:95], v39 offset:54272
  v_mfma_f32_16x16x32_bf16 v[60:63], v[116:119], v[124:127], v[60:63]
  s_waitcnt lgkmcnt(0)
  v_mfma_f32_16x16x32_bf16 v[48:51], v[64:67], v[72:75], v[48:51]
  s_barrier
  v_mfma_f32_16x16x32_bf16 v[52:55], v[68:71], v[72:75], v[52:55]
  ds_read_b64_tr_b16 v[96:97], v40 offset:34816
  ds_read_b64_tr_b16 v[98:99], v40 offset:36864
  v_mfma_f32_16x16x32_bf16 v[56:59], v[64:67], v[76:79], v[56:59]
  ds_read_b64_tr_b16 v[100:101], v42 offset:34816
  ds_read_b64_tr_b16 v[102:103], v42 offset:36864
  v_mfma_f32_16x16x32_bf16 v[60:63], v[68:71], v[76:79], v[60:63]
  ds_read_b128 v[104:107], v39 offset:57344
  ds_read_b128 v[108:111], v39 offset:58368
  v_mfma_f32_16x16x32_bf16 v[48:51], v[80:83], v[88:91], v[48:51]
  ds_read_b64_tr_b16 v[112:113], v40 offset:30720
  ds_read_b64_tr_b16 v[114:115], v40 offset:32768
  v_mfma_f32_16x16x32_bf16 v[52:55], v[84:87], v[88:91], v[52:55]
  ds_read_b64_tr_b16 v[116:117], v42 offset:30720
  ds_read_b64_tr_b16 v[118:119], v42 offset:32768
  v_mfma_f32_16x16x32_bf16 v[56:59], v[80:83], v[92:95], v[56:59]
  ds_read_b128 v[120:123], v39 offset:61440
  ds_read_b128 v[124:127], v39 offset:62464
  v_mfma_f32_16x16x32_bf16 v[60:63], v[84:87], v[92:95], v[60:63]
  s_waitcnt lgkmcnt(0)
  s_barrier
  v_mfma_f32_16x16x32_bf16 v[48:51], v[96:99], v[104:107], v[48:51]
  v_mfma_f32_16x16x32_bf16 v[52:55], v[100:103], v[104:107], v[52:55]
  v_mfma_f32_16x16x32_bf16 v[56:59], v[96:99], v[108:111], v[56:59]
  v_mfma_f32_16x16x32_bf16 v[60:63], v[100:103], v[108:111], v[60:63]
  v_mfma_f32_16x16x32_bf16 v[48:51], v[112:115], v[120:123], v[48:51]
  v_mfma_f32_16x16x32_bf16 v[52:55], v[116:119], v[120:123], v[52:55]
  v_mfma_f32_16x16x32_bf16 v[56:59], v[112:115], v[124:127], v[56:59]
  v_mfma_f32_16x16x32_bf16 v[60:63], v[116:119], v[124:127], v[60:63]
  s_lshl_b32 s53, s40, 16
  s_lshr_b32 s54, s4, 1
  s_lshl_b32 s54, s54, 15
  s_add_u32 s53, s53, s54
  s_lshl_b32 s54, s41, 11
  s_add_u32 s53, s53, s54
  s_and_b32 s54, s4, 1
  s_lshl_b32 s54, s54, 10
  s_add_u32 s53, s53, s54
  s_mul_i32 s54, s42, 221184
  s_add_u32 s53, s53, s54
  s_add_u32 s53, s53, 4325376
  v_cvt_pk_bf16_f32 v6, v48, v49
  v_cvt_pk_bf16_f32 v7, v50, v51
  v_lshlrev_b32 v48, 16, v6
  v_and_b32 v49, 0xffff0000, v6
  v_lshlrev_b32 v50, 16, v7
  v_and_b32 v51, 0xffff0000, v7
  v_lshlrev_b32 v6, 16, v28
  v_and_b32 v7, 0xffff0000, v28
  v_lshlrev_b32 v8, 16, v29
  v_and_b32 v9, 0xffff0000, v29
  v_add_f32 v48, v48, v6
  v_add_f32 v49, v49, v7
  v_add_f32 v50, v50, v8
  v_add_f32 v51, v51, v9
  v_cvt_pk_bf16_f32 v16, v48, v49
  v_cvt_pk_bf16_f32 v17, v50, v51
  v_cvt_pk_bf16_f32 v6, v52, v53
  v_cvt_pk_bf16_f32 v7, v54, v55
  v_lshlrev_b32 v52, 16, v6
  v_and_b32 v53, 0xffff0000, v6
  v_lshlrev_b32 v54, 16, v7
  v_and_b32 v55, 0xffff0000, v7
  v_lshlrev_b32 v6, 16, v30
  v_and_b32 v7, 0xffff0000, v30
  v_lshlrev_b32 v8, 16, v31
  v_and_b32 v9, 0xffff0000, v31
  v_add_f32 v52, v52, v6
  v_add_f32 v53, v53, v7
  v_add_f32 v54, v54, v8
  v_add_f32 v55, v55, v9
  v_cvt_pk_bf16_f32 v18, v52, v53
  v_cvt_pk_bf16_f32 v19, v54, v55
  buffer_store_dwordx4 v[16:19], v5, s[36:39], s53 offen
  s_add_u32 s53, s53, 16384
  v_cvt_pk_bf16_f32 v6, v56, v57
  v_cvt_pk_bf16_f32 v7, v58, v59
  v_lshlrev_b32 v56, 16, v6
  v_and_b32 v57, 0xffff0000, v6
  v_lshlrev_b32 v58, 16, v7
  v_and_b32 v59, 0xffff0000, v7
  v_lshlrev_b32 v6, 16, v32
  v_and_b32 v7, 0xffff0000, v32
  v_lshlrev_b32 v8, 16, v33
  v_and_b32 v9, 0xffff0000, v33
  v_add_f32 v56, v56, v6
  v_add_f32 v57, v57, v7
  v_add_f32 v58, v58, v8
  v_add_f32 v59, v59, v9
  v_cvt_pk_bf16_f32 v20, v56, v57
  v_cvt_pk_bf16_f32 v21, v58, v59
  v_cvt_pk_bf16_f32 v6, v60, v61
  v_cvt_pk_bf16_f32 v7, v62, v63
  v_lshlrev_b32 v60, 16, v6
  v_and_b32 v61, 0xffff0000, v6
  v_lshlrev_b32 v62, 16, v7
  v_and_b32 v63, 0xffff0000, v7
  v_lshlrev_b32 v6, 16, v34
  v_and_b32 v7, 0xffff0000, v34
  v_lshlrev_b32 v8, 16, v35
  v_and_b32 v9, 0xffff0000, v35
  v_add_f32 v60, v60, v6
  v_add_f32 v61, v61, v7
  v_add_f32 v62, v62, v8
  v_add_f32 v63, v63, v9
  v_cvt_pk_bf16_f32 v22, v60, v61
  v_cvt_pk_bf16_f32 v23, v62, v63
  buffer_store_dwordx4 v[20:23], v5, s[36:39], s53 offen
  s_mul_i32 s54, s5, 2048
  s_add_u32 s54, s54, 9961984
  s_lshl_b32 s55, s6, 4
  s_add_u32 s54, s54, s55
  s_lshl_b32 s55, s4, 2
  s_add_u32 s54, s54, s55
  v_mov_b32 v6, 0
  s_waitcnt vmcnt(0)
  s_mov_b64 exec, 1
  buffer_store_dword v36, v6, s[36:39], s54 offen
  s_mov_b64 exec, -1
  v_bfe_u32 v6, v2, 2, 2
  v_lshl_add_u32 v6, v4, 2, v6
  v_mul_u32_u24 v6, 192, v6
  v_and_b32 v7, 3, v2
  v_lshl_add_u32 v6, v7, 3, v6
  v_and_b32 v7, 1, v4
  v_lshlrev_b32 v7, 5, v7
  v_add_u32 v46, v6, v7
  v_sub_u32 v47, v6, v7
  v_add_u32 v47, 32, v47
  s_lshl_b32 s53, s4, 11
  v_add_u32 v48, s53, v5
  v_add_u32 v49, 65536, v46
  v_add_u32 v50, 131072, v46
  v_add_u32 v51, 65536, v47
  v_add_u32 v52, 131072, v47
  v_add_u32 v53, 65536, v48
  v_add_u32 v54, 131072, v48
  v_mov_b32 v56, 0
  v_mov_b32 v57, 0
  v_mov_b32 v58, 0
  v_mov_b32 v59, 0
  v_mov_b32 v60, 0
  v_mov_b32 v61, 0
  v_mov_b32 v62, 0
  v_mov_b32 v63, 0
  v_mov_b32 v64, 0
  v_mov_b32 v65, 0
  v_mov_b32 v66, 0
  v_mov_b32 v67, 0
  v_mov_b32 v68, 0
  v_mov_b32 v69, 0
  v_mov_b32 v70, 0
  v_mov_b32 v71, 0
  v_mov_b32 v72, 0
  v_mov_b32 v73, 0
  v_mov_b32 v74, 0
  v_mov_b32 v75, 0
  v_mov_b32 v76, 0
  v_mov_b32 v77, 0
  v_mov_b32 v78, 0
  v_mov_b32 v79, 0
  v_mov_b32 v80, 0
  v_mov_b32 v81, 0
  v_mov_b32 v82, 0
  v_mov_b32 v83, 0
  v_mov_b32 v84, 0
  v_mov_b32 v85, 0
  v_mov_b32 v86, 0
  v_mov_b32 v87, 0
  v_mov_b32 v88, 0
  v_mov_b32 v89, 0
  v_mov_b32 v90, 0
  v_mov_b32 v91, 0
  v_mov_b32 v92, 0
  v_mov_b32 v93, 0
  v_mov_b32 v94, 0
  v_mov_b32 v95, 0
  v_mov_b32 v96, 0
  v_mov_b32 v97, 0
  v_mov_b32 v98, 0
  v_mov_b32 v99, 0
  v_mov_b32 v100, 0
  v_mov_b32 v101, 0
  v_mov_b32 v102, 0
  v_mov_b32 v103, 0
  v_mov_b32 v104, 0
  v_mov_b32 v105, 0
  v_mov_b32 v106, 0
  v_mov_b32 v107, 0
  v_mov_b32 v108, 0
  v_mov_b32 v109, 0
  v_mov_b32 v110, 0
  v_mov_b32 v111, 0
  v_mov_b32 v112, 0
  v_mov_b32 v113, 0
  v_mov_b32 v114, 0
  v_mov_b32 v115, 0
  v_mov_b32 v116, 0
  v_mov_b32 v117, 0
  v_mov_b32 v118, 0
  v_mov_b32 v119, 0
  v_mov_b32 v120, 0
  v_mov_b32 v121, 0
  v_mov_b32 v122, 0
  v_mov_b32 v123, 0
  v_mov_b32 v124, 0
  v_mov_b32 v125, 0
  v_mov_b32 v126, 0
  v_mov_b32 v127, 0
  v_mov_b32 v128, 0
  v_mov_b32 v129, 0
  v_mov_b32 v130, 0
  v_mov_b32 v131, 0
  v_mov_b32 v132, 0
  v_mov_b32 v133, 0
  v_mov_b32 v134, 0
  v_mov_b32 v135, 0
  v_mov_b32 v136, 0
  v_mov_b32 v137, 0
  v_mov_b32 v138, 0
  v_mov_b32 v139, 0
  v_mov_b32 v140, 0
  v_mov_b32 v141, 0
  v_mov_b32 v142, 0
  v_mov_b32 v143, 0
  v_cmp_eq_u32 s[60:61], 0, v3
  s_waitcnt lgkmcnt(0)
  s_barrier
  ds_read_b128 v[168:171], v48 offset:16384
  ds_read_b128 v[172:175], v48 offset:17408
  ds_read_b64_tr_b16 v[144:145], v49 offset:18432
  ds_read_b64_tr_b16 v[146:147], v49 offset:21504
  ds_read_b64_tr_b16 v[148:149], v51 offset:18432
  ds_read_b64_tr_b16 v[150:151], v51 offset:21504
  ds_read_b64_tr_b16 v[152:153], v49 offset:18496
  ds_read_b64_tr_b16 v[154:155], v49 offset:21568
  ds_read_b64_tr_b16 v[156:157], v51 offset:18496
  ds_read_b64_tr_b16 v[158:159], v51 offset:21568
  ds_read_b64_tr_b16 v[160:161], v49 offset:18560
  ds_read_b64_tr_b16 v[162:163], v49 offset:21632
  ds_read_b64_tr_b16 v[164:165], v51 offset:18560
  ds_read_b64_tr_b16 v[166:167], v51 offset:21632
  s_waitcnt lgkmcnt(0)
  v_mfma_f32_16x16x32_bf16 v[104:107], v[24:27], v[168:171], v[104:107]
  ds_read_b128 v[200:203], v48 offset:24576
  v_mfma_f32_16x16x32_bf16 v[112:115], v[168:171], v[168:171], v[112:115]
  ds_read_b128 v[204:207], v48 offset:25600
  v_mfma_f32_16x16x32_bf16 v[108:111], v[24:27], v[172:175], v[108:111]
  ds_read_b64_tr_b16 v[176:177], v49 offset:24576
  v_mfma_f32_16x16x32_bf16 v[116:119], v[172:175], v[172:175], v[116:119]
  ds_read_b64_tr_b16 v[178:179], v49 offset:27648
  v_mfma_f32_16x16x32_bf16 v[56:59], v[144:147], v[168:171], v[56:59]
  ds_read_b64_tr_b16 v[180:181], v51 offset:24576
  v_mfma_f32_16x16x32_bf16 v[80:83], v[144:147], v[172:175], v[80:83]
  ds_read_b64_tr_b16 v[182:183], v51 offset:27648
  v_mfma_f32_16x16x32_bf16 v[60:63], v[148:151], v[168:171], v[60:63]
  ds_read_b64_tr_b16 v[184:185], v49 offset:24640
  v_mfma_f32_16x16x32_bf16 v[84:87], v[148:151], v[172:175], v[84:87]
  ds_read_b64_tr_b16 v[186:187], v49 offset:27712
  v_mfma_f32_16x16x32_bf16 v[64:67], v[152:155], v[168:171], v[64:67]
  ds_read_b64_tr_b16 v[188:189], v51 offset:24640
  v_mfma_f32_16x16x32_bf16 v[88:91], v[152:155], v[172:175], v[88:91]
  ds_read_b64_tr_b16 v[190:191], v51 offset:27712
  v_mfma_f32_16x16x32_bf16 v[68:71], v[156:159], v[168:171], v[68:71]
  ds_read_b64_tr_b16 v[192:193], v49 offset:24704
  v_mfma_f32_16x16x32_bf16 v[92:95], v[156:159], v[172:175], v[92:95]
  ds_read_b64_tr_b16 v[194:195], v49 offset:27776
  v_mfma_f32_16x16x32_bf16 v[72:75], v[160:163], v[168:171], v[72:75]
  ds_read_b64_tr_b16 v[196:197], v51 offset:24704
  v_mfma_f32_16x16x32_bf16 v[96:99], v[160:163], v[172:175], v[96:99]
  ds_read_b64_tr_b16 v[198:199], v51 offset:27776
  v_mfma_f32_16x16x32_bf16 v[76:79], v[164:167], v[168:171], v[76:79]
  v_mfma_f32_16x16x32_bf16 v[100:103], v[164:167], v[172:175], v[100:103]
  s_cmp_lg_u32 s4, 0
  s_cbranch_scc1 L_C_cs0
  v_mfma_f32_16x16x32_bf16 v[120:123], v[144:147], v[24:27], v[120:123]
  v_mfma_f32_16x16x32_bf16 v[124:127], v[148:151], v[24:27], v[124:127]
  v_mfma_f32_16x16x32_bf16 v[128:131], v[152:155], v[24:27], v[128:131]
  v_mfma_f32_16x16x32_bf16 v[132:135], v[156:159], v[24:27], v[132:135]
  v_mfma_f32_16x16x32_bf16 v[136:139], v[160:163], v[24:27], v[136:139]
  v_mfma_f32_16x16x32_bf16 v[140:143], v[164:167], v[24:27], v[140:143]
L_C_cs0:
  s_waitcnt lgkmcnt(0)
  v_mfma_f32_16x16x32_bf16 v[104:107], v[24:27], v[200:203], v[104:107]
  s_barrier
  v_mfma_f32_16x16x32_bf16 v[112:115], v[200:203], v[200:203], v[112:115]
  ds_read_b128 v[168:171], v48 offset:32768
  v_mfma_f32_16x16x32_bf16 v[108:111], v[24:27], v[204:207], v[108:111]
  ds_read_b128 v[172:175], v48 offset:33792
  v_mfma_f32_16x16x32_bf16 v[116:119], v[204:207], v[204:207], v[116:119]
  ds_read_b64_tr_b16 v[144:145], v49 offset:6144
  v_mfma_f32_16x16x32_bf16 v[56:59], v[176:179], v[200:203], v[56:59]
  ds_read_b64_tr_b16 v[146:147], v49 offset:9216
  v_mfma_f32_16x16x32_bf16 v[80:83], v[176:179], v[204:207], v[80:83]
  ds_read_b64_tr_b16 v[148:149], v51 offset:6144
  v_mfma_f32_16x16x32_bf16 v[60:63], v[180:183], v[200:203], v[60:63]
  ds_read_b64_tr_b16 v[150:151], v51 offset:9216
  v_mfma_f32_16x16x32_bf16 v[84:87], v[180:183], v[204:207], v[84:87]
  ds_read_b64_tr_b16 v[152:153], v49 offset:6208
  v_mfma_f32_16x16x32_bf16 v[64:67], v[184:187], v[200:203], v[64:67]
  ds_read_b64_tr_b16 v[154:155], v49 offset:9280
  v_mfma_f32_16x16x32_bf16 v[88:91], v[184:187], v[204:207], v[88:91]
  ds_read_b64_tr_b16 v[156:157], v51 offset:6208
  v_mfma_f32_16x16x32_bf16 v[68:71], v[188:191], v[200:203], v[68:71]
  ds_read_b64_tr_b16 v[158:159], v51 offset:9280
  v_mfma_f32_16x16x32_bf16 v[92:95], v[188:191], v[204:207], v[92:95]
  ds_read_b64_tr_b16 v[160:161], v49 offset:6272
  v_mfma_f32_16x16x32_bf16 v[72:75], v[192:195], v[200:203], v[72:75]
  ds_read_b64_tr_b16 v[162:163], v49 offset:9344
  v_mfma_f32_16x16x32_bf16 v[96:99], v[192:195], v[204:207], v[96:99]
  ds_read_b64_tr_b16 v[164:165], v51 offset:6272
  v_mfma_f32_16x16x32_bf16 v[76:79], v[196:199], v[200:203], v[76:79]
  ds_read_b64_tr_b16 v[166:167], v51 offset:9344
  v_mfma_f32_16x16x32_bf16 v[100:103], v[196:199], v[204:207], v[100:103]
  s_cmp_lg_u32 s4, 1
  s_cbranch_scc1 L_C_cs1
  v_mfma_f32_16x16x32_bf16 v[120:123], v[176:179], v[24:27], v[120:123]
  v_mfma_f32_16x16x32_bf16 v[124:127], v[180:183], v[24:27], v[124:127]
  v_mfma_f32_16x16x32_bf16 v[128:131], v[184:187], v[24:27], v[128:131]
  v_mfma_f32_16x16x32_bf16 v[132:135], v[188:191], v[24:27], v[132:135]
  v_mfma_f32_16x16x32_bf16 v[136:139], v[192:195], v[24:27], v[136:139]
  v_mfma_f32_16x16x32_bf16 v[140:143], v[196:199], v[24:27], v[140:143]
L_C_cs1:
  s_waitcnt lgkmcnt(0)
  v_mfma_f32_16x16x32_bf16 v[104:107], v[24:27], v[168:171], v[104:107]
  ds_read_b128 v[200:203], v48 offset:40960
  v_mfma_f32_16x16x32_bf16 v[112:115], v[168:171], v[168:171], v[112:115]
  ds_read_b128 v[204:207], v48 offset:41984
  v_mfma_f32_16x16x32_bf16 v[108:111], v[24:27], v[172:175], v[108:111]
  ds_read_b64_tr_b16 v[176:177], v49 offset:12288
  v_mfma_f32_16x16x32_bf16 v[116:119], v[172:175], v[172:175], v[116:119]
  ds_read_b64_tr_b16 v[178:179], v49 offset:15360
  v_mfma_f32_16x16x32_bf16 v[56:59], v[144:147], v[168:171], v[56:59]
  ds_read_b64_tr_b16 v[180:181], v51 offset:12288
  v_mfma_f32_16x16x32_bf16 v[80:83], v[144:147], v[172:175], v[80:83]
  ds_read_b64_tr_b16 v[182:183], v51 offset:15360
  v_mfma_f32_16x16x32_bf16 v[60:63], v[148:151], v[168:171], v[60:63]
  ds_read_b64_tr_b16 v[184:185], v49 offset:12352
  v_mfma_f32_16x16x32_bf16 v[84:87], v[148:151], v[172:175], v[84:87]
  ds_read_b64_tr_b16 v[186:187], v49 offset:15424
  v_mfma_f32_16x16x32_bf16 v[64:67], v[152:155], v[168:171], v[64:67]
  ds_read_b64_tr_b16 v[188:189], v51 offset:12352
  v_mfma_f32_16x16x32_bf16 v[88:91], v[152:155], v[172:175], v[88:91]
  ds_read_b64_tr_b16 v[190:191], v51 offset:15424
  v_mfma_f32_16x16x32_bf16 v[68:71], v[156:159], v[168:171], v[68:71]
  ds_read_b64_tr_b16 v[192:193], v49 offset:12416
  v_mfma_f32_16x16x32_bf16 v[92:95], v[156:159], v[172:175], v[92:95]
  ds_read_b64_tr_b16 v[194:195], v49 offset:15488
  v_mfma_f32_16x16x32_bf16 v[72:75], v[160:163], v[168:171], v[72:75]
  ds_read_b64_tr_b16 v[196:197], v51 offset:12416
  v_mfma_f32_16x16x32_bf16 v[96:99], v[160:163], v[172:175], v[96:99]
  ds_read_b64_tr_b16 v[198:199], v51 offset:15488
  v_mfma_f32_16x16x32_bf16 v[76:79], v[164:167], v[168:171], v[76:79]
  v_mfma_f32_16x16x32_bf16 v[100:103], v[164:167], v[172:175], v[100:103]
  s_cmp_lg_u32 s4, 2
  s_cbranch_scc1 L_C_cs2
  v_mfma_f32_16x16x32_bf16 v[120:123], v[144:147], v[24:27], v[120:123]
  v_mfma_f32_16x16x32_bf16 v[124:127], v[148:151], v[24:27], v[124:127]
  v_mfma_f32_16x16x32_bf16 v[128:131], v[152:155], v[24:27], v[128:131]
  v_mfma_f32_16x16x32_bf16 v[132:135], v[156:159], v[24:27], v[132:135]
  v_mfma_f32_16x16x32_bf16 v[136:139], v[160:163], v[24:27], v[136:139]
  v_mfma_f32_16x16x32_bf16 v[140:143], v[164:167], v[24:27], v[140:143]
L_C_cs2:
  s_waitcnt lgkmcnt(0)
  v_mfma_f32_16x16x32_bf16 v[104:107], v[24:27], v[200:203], v[104:107]
  s_barrier
  v_mfma_f32_16x16x32_bf16 v[112:115], v[200:203], v[200:203], v[112:115]
  ds_read_b128 v[168:171], v48 offset:49152
  v_mfma_f32_16x16x32_bf16 v[108:111], v[24:27], v[204:207], v[108:111]
  ds_read_b128 v[172:175], v48 offset:50176
  v_mfma_f32_16x16x32_bf16 v[116:119], v[204:207], v[204:207], v[116:119]
  ds_read_b64_tr_b16 v[144:145], v50 offset:18432
  v_mfma_f32_16x16x32_bf16 v[56:59], v[176:179], v[200:203], v[56:59]
  ds_read_b64_tr_b16 v[146:147], v50 offset:21504
  v_mfma_f32_16x16x32_bf16 v[80:83], v[176:179], v[204:207], v[80:83]
  ds_read_b64_tr_b16 v[148:149], v52 offset:18432
  v_mfma_f32_16x16x32_bf16 v[60:63], v[180:183], v[200:203], v[60:63]
  ds_read_b64_tr_b16 v[150:151], v52 offset:21504
  v_mfma_f32_16x16x32_bf16 v[84:87], v[180:183], v[204:207], v[84:87]
  ds_read_b64_tr_b16 v[152:153], v50 offset:18496
  v_mfma_f32_16x16x32_bf16 v[64:67], v[184:187], v[200:203], v[64:67]
  ds_read_b64_tr_b16 v[154:155], v50 offset:21568
  v_mfma_f32_16x16x32_bf16 v[88:91], v[184:187], v[204:207], v[88:91]
  ds_read_b64_tr_b16 v[156:157], v52 offset:18496
  v_mfma_f32_16x16x32_bf16 v[68:71], v[188:191], v[200:203], v[68:71]
  ds_read_b64_tr_b16 v[158:159], v52 offset:21568
  v_mfma_f32_16x16x32_bf16 v[92:95], v[188:191], v[204:207], v[92:95]
  ds_read_b64_tr_b16 v[160:161], v50 offset:18560
  v_mfma_f32_16x16x32_bf16 v[72:75], v[192:195], v[200:203], v[72:75]
  ds_read_b64_tr_b16 v[162:163], v50 offset:21632
  v_mfma_f32_16x16x32_bf16 v[96:99], v[192:195], v[204:207], v[96:99]
  ds_read_b64_tr_b16 v[164:165], v52 offset:18560
  v_mfma_f32_16x16x32_bf16 v[76:79], v[196:199], v[200:203], v[76:79]
  ds_read_b64_tr_b16 v[166:167], v52 offset:21632
  v_mfma_f32_16x16x32_bf16 v[100:103], v[196:199], v[204:207], v[100:103]
  s_cmp_lg_u32 s4, 3
  s_cbranch_scc1 L_C_cs3
  v_mfma_f32_16x16x32_bf16 v[120:123], v[176:179], v[24:27], v[120:123]
  v_mfma_f32_16x16x32_bf16 v[124:127], v[180:183], v[24:27], v[124:127]
  v_mfma_f32_16x16x32_bf16 v[128:131], v[184:187], v[24:27], v[128:131]
  v_mfma_f32_16x16x32_bf16 v[132:135], v[188:191], v[24:27], v[132:135]
  v_mfma_f32_16x16x32_bf16 v[136:139], v[192:195], v[24:27], v[136:139]
  v_mfma_f32_16x16x32_bf16 v[140:143], v[196:199], v[24:27], v[140:143]
L_C_cs3:
  s_waitcnt lgkmcnt(0)
  v_mfma_f32_16x16x32_bf16 v[104:107], v[24:27], v[168:171], v[104:107]
  ds_read_b128 v[200:203], v48 offset:57344
  v_mfma_f32_16x16x32_bf16 v[112:115], v[168:171], v[168:171], v[112:115]
  ds_read_b128 v[204:207], v48 offset:58368
  v_mfma_f32_16x16x32_bf16 v[108:111], v[24:27], v[172:175], v[108:111]
  ds_read_b64_tr_b16 v[176:177], v50 offset:24576
  v_mfma_f32_16x16x32_bf16 v[116:119], v[172:175], v[172:175], v[116:119]
  ds_read_b64_tr_b16 v[178:179], v50 offset:27648
  v_mfma_f32_16x16x32_bf16 v[56:59], v[144:147], v[168:171], v[56:59]
  ds_read_b64_tr_b16 v[180:181], v52 offset:24576
  v_mfma_f32_16x16x32_bf16 v[80:83], v[144:147], v[172:175], v[80:83]
  ds_read_b64_tr_b16 v[182:183], v52 offset:27648
  v_mfma_f32_16x16x32_bf16 v[60:63], v[148:151], v[168:171], v[60:63]
  ds_read_b64_tr_b16 v[184:185], v50 offset:24640
  v_mfma_f32_16x16x32_bf16 v[84:87], v[148:151], v[172:175], v[84:87]
  ds_read_b64_tr_b16 v[186:187], v50 offset:27712
  v_mfma_f32_16x16x32_bf16 v[64:67], v[152:155], v[168:171], v[64:67]
  ds_read_b64_tr_b16 v[188:189], v52 offset:24640
  v_mfma_f32_16x16x32_bf16 v[88:91], v[152:155], v[172:175], v[88:91]
  ds_read_b64_tr_b16 v[190:191], v52 offset:27712
  v_mfma_f32_16x16x32_bf16 v[68:71], v[156:159], v[168:171], v[68:71]
  ds_read_b64_tr_b16 v[192:193], v50 offset:24704
  v_mfma_f32_16x16x32_bf16 v[92:95], v[156:159], v[172:175], v[92:95]
  ds_read_b64_tr_b16 v[194:195], v50 offset:27776
  v_mfma_f32_16x16x32_bf16 v[72:75], v[160:163], v[168:171], v[72:75]
  ds_read_b64_tr_b16 v[196:197], v52 offset:24704
  v_mfma_f32_16x16x32_bf16 v[96:99], v[160:163], v[172:175], v[96:99]
  ds_read_b64_tr_b16 v[198:199], v52 offset:27776
  v_mfma_f32_16x16x32_bf16 v[76:79], v[164:167], v[168:171], v[76:79]
  v_mfma_f32_16x16x32_bf16 v[100:103], v[164:167], v[172:175], v[100:103]
  s_cmp_lg_u32 s4, 0
  s_cbranch_scc1 L_C_cs4
  v_mfma_f32_16x16x32_bf16 v[120:123], v[144:147], v[24:27], v[120:123]
  v_mfma_f32_16x16x32_bf16 v[124:127], v[148:151], v[24:27], v[124:127]
  v_mfma_f32_16x16x32_bf16 v[128:131], v[152:155], v[24:27], v[128:131]
  v_mfma_f32_16x16x32_bf16 v[132:135], v[156:159], v[24:27], v[132:135]
  v_mfma_f32_16x16x32_bf16 v[136:139], v[160:163], v[24:27], v[136:139]
  v_mfma_f32_16x16x32_bf16 v[140:143], v[164:167], v[24:27], v[140:143]
L_C_cs4:
  s_waitcnt lgkmcnt(0)
  v_mfma_f32_16x16x32_bf16 v[104:107], v[24:27], v[200:203], v[104:107]
  s_barrier
  v_mfma_f32_16x16x32_bf16 v[112:115], v[200:203], v[200:203], v[112:115]
  ds_read_b128 v[168:171], v53 offset:30720
  v_mfma_f32_16x16x32_bf16 v[108:111], v[24:27], v[204:207], v[108:111]
  ds_read_b128 v[172:175], v53 offset:31744
  v_mfma_f32_16x16x32_bf16 v[116:119], v[204:207], v[204:207], v[116:119]
  ds_read_b64_tr_b16 v[144:145], v46 offset:4096
  v_mfma_f32_16x16x32_bf16 v[56:59], v[176:179], v[200:203], v[56:59]
  ds_read_b64_tr_b16 v[146:147], v46 offset:7168
  v_mfma_f32_16x16x32_bf16 v[80:83], v[176:179], v[204:207], v[80:83]
  ds_read_b64_tr_b16 v[148:149], v47 offset:4096
  v_mfma_f32_16x16x32_bf16 v[60:63], v[180:183], v[200:203], v[60:63]
  ds_read_b64_tr_b16 v[150:151], v47 offset:7168
  v_mfma_f32_16x16x32_bf16 v[84:87], v[180:183], v[204:207], v[84:87]
  ds_read_b64_tr_b16 v[152:153], v46 offset:4160
  v_mfma_f32_16x16x32_bf16 v[64:67], v[184:187], v[200:203], v[64:67]
  ds_read_b64_tr_b16 v[154:155], v46 offset:7232
  v_mfma_f32_16x16x32_bf16 v[88:91], v[184:187], v[204:207], v[88:91]
  ds_read_b64_tr_b16 v[156:157], v47 offset:4160
  v_mfma_f32_16x16x32_bf16 v[68:71], v[188:191], v[200:203], v[68:71]
  ds_read_b64_tr_b16 v[158:159], v47 offset:7232
  v_mfma_f32_16x16x32_bf16 v[92:95], v[188:191], v[204:207], v[92:95]
  ds_read_b64_tr_b16 v[160:161], v46 offset:4224
  v_mfma_f32_16x16x32_bf16 v[72:75], v[192:195], v[200:203], v[72:75]
  ds_read_b64_tr_b16 v[162:163], v46 offset:7296
  v_mfma_f32_16x16x32_bf16 v[96:99], v[192:195], v[204:207], v[96:99]
  ds_read_b64_tr_b16 v[164:165], v47 offset:4224
  v_mfma_f32_16x16x32_bf16 v[76:79], v[196:199], v[200:203], v[76:79]
  ds_read_b64_tr_b16 v[166:167], v47 offset:7296
  v_mfma_f32_16x16x32_bf16 v[100:103], v[196:199], v[204:207], v[100:103]
  s_cmp_lg_u32 s4, 1
  s_cbranch_scc1 L_C_cs5
  v_mfma_f32_16x16x32_bf16 v[120:123], v[176:179], v[24:27], v[120:123]
  v_mfma_f32_16x16x32_bf16 v[124:127], v[180:183], v[24:27], v[124:127]
  v_mfma_f32_16x16x32_bf16 v[128:131], v[184:187], v[24:27], v[128:131]
  v_mfma_f32_16x16x32_bf16 v[132:135], v[188:191], v[24:27], v[132:135]
  v_mfma_f32_16x16x32_bf16 v[136:139], v[192:195], v[24:27], v[136:139]
  v_mfma_f32_16x16x32_bf16 v[140:143], v[196:199], v[24:27], v[140:143]
L_C_cs5:
  s_waitcnt lgkmcnt(0)
  v_mfma_f32_16x16x32_bf16 v[104:107], v[24:27], v[168:171], v[104:107]
  ds_read_b128 v[200:203], v53 offset:38912
  v_mfma_f32_16x16x32_bf16 v[112:115], v[168:171], v[168:171], v[112:115]
  ds_read_b128 v[204:207], v53 offset:39936
  v_mfma_f32_16x16x32_bf16 v[108:111], v[24:27], v[172:175], v[108:111]
  ds_read_b64_tr_b16 v[176:177], v46 offset:10240
  v_mfma_f32_16x16x32_bf16 v[116:119], v[172:175], v[172:175], v[116:119]
  ds_read_b64_tr_b16 v[178:179], v46 offset:13312
  v_mfma_f32_16x16x32_bf16 v[56:59], v[144:147], v[168:171], v[56:59]
  ds_read_b64_tr_b16 v[180:181], v47 offset:10240
  v_mfma_f32_16x16x32_bf16 v[80:83], v[144:147], v[172:175], v[80:83]
  ds_read_b64_tr_b16 v[182:183], v47 offset:13312
  v_mfma_f32_16x16x32_bf16 v[60:63], v[148:151], v[168:171], v[60:63]
  ds_read_b64_tr_b16 v[184:185], v46 offset:10304
  v_mfma_f32_16x16x32_bf16 v[84:87], v[148:151], v[172:175], v[84:87]
  ds_read_b64_tr_b16 v[186:187], v46 offset:13376
  v_mfma_f32_16x16x32_bf16 v[64:67], v[152:155], v[168:171], v[64:67]
  ds_read_b64_tr_b16 v[188:189], v47 offset:10304
  v_mfma_f32_16x16x32_bf16 v[88:91], v[152:155], v[172:175], v[88:91]
  ds_read_b64_tr_b16 v[190:191], v47 offset:13376
  v_mfma_f32_16x16x32_bf16 v[68:71], v[156:159], v[168:171], v[68:71]
  ds_read_b64_tr_b16 v[192:193], v46 offset:10368
  v_mfma_f32_16x16x32_bf16 v[92:95], v[156:159], v[172:175], v[92:95]
  ds_read_b64_tr_b16 v[194:195], v46 offset:13440
  v_mfma_f32_16x16x32_bf16 v[72:75], v[160:163], v[168:171], v[72:75]
  ds_read_b64_tr_b16 v[196:197], v47 offset:10368
  v_mfma_f32_16x16x32_bf16 v[96:99], v[160:163], v[172:175], v[96:99]
  ds_read_b64_tr_b16 v[198:199], v47 offset:13440
  v_mfma_f32_16x16x32_bf16 v[76:79], v[164:167], v[168:171], v[76:79]
  v_mfma_f32_16x16x32_bf16 v[100:103], v[164:167], v[172:175], v[100:103]
  s_cmp_lg_u32 s4, 2
  s_cbranch_scc1 L_C_cs6
  v_mfma_f32_16x16x32_bf16 v[120:123], v[144:147], v[24:27], v[120:123]
  v_mfma_f32_16x16x32_bf16 v[124:127], v[148:151], v[24:27], v[124:127]
  v_mfma_f32_16x16x32_bf16 v[128:131], v[152:155], v[24:27], v[128:131]
  v_mfma_f32_16x16x32_bf16 v[132:135], v[156:159], v[24:27], v[132:135]
  v_mfma_f32_16x16x32_bf16 v[136:139], v[160:163], v[24:27], v[136:139]
  v_mfma_f32_16x16x32_bf16 v[140:143], v[164:167], v[24:27], v[140:143]
L_C_cs6:
  s_waitcnt lgkmcnt(0)
  v_mfma_f32_16x16x32_bf16 v[104:107], v[24:27], v[200:203], v[104:107]
  s_barrier
  v_mfma_f32_16x16x32_bf16 v[112:115], v[200:203], v[200:203], v[112:115]
  ds_read_b128 v[168:171], v53 offset:47104
  v_mfma_f32_16x16x32_bf16 v[108:111], v[24:27], v[204:207], v[108:111]
  ds_read_b128 v[172:175], v53 offset:48128
  v_mfma_f32_16x16x32_bf16 v[116:119], v[204:207], v[204:207], v[116:119]
  ds_read_b64_tr_b16 v[144:145], v50 offset:6144
  v_mfma_f32_16x16x32_bf16 v[56:59], v[176:179], v[200:203], v[56:59]
  ds_read_b64_tr_b16 v[146:147], v50 offset:9216
  v_mfma_f32_16x16x32_bf16 v[80:83], v[176:179], v[204:207], v[80:83]
  ds_read_b64_tr_b16 v[148:149], v52 offset:6144
  v_mfma_f32_16x16x32_bf16 v[60:63], v[180:183], v[200:203], v[60:63]
  ds_read_b64_tr_b16 v[150:151], v52 offset:9216
  v_mfma_f32_16x16x32_bf16 v[84:87], v[180:183], v[204:207], v[84:87]
  ds_read_b64_tr_b16 v[152:153], v50 offset:6208
  v_mfma_f32_16x16x32_bf16 v[64:67], v[184:187], v[200:203], v[64:67]
  ds_read_b64_tr_b16 v[154:155], v50 offset:9280
  v_mfma_f32_16x16x32_bf16 v[88:91], v[184:187], v[204:207], v[88:91]
  ds_read_b64_tr_b16 v[156:157], v52 offset:6208
  v_mfma_f32_16x16x32_bf16 v[68:71], v[188:191], v[200:203], v[68:71]
  ds_read_b64_tr_b16 v[158:159], v52 offset:9280
  v_mfma_f32_16x16x32_bf16 v[92:95], v[188:191], v[204:207], v[92:95]
  ds_read_b64_tr_b16 v[160:161], v50 offset:6272
  v_mfma_f32_16x16x32_bf16 v[72:75], v[192:195], v[200:203], v[72:75]
  ds_read_b64_tr_b16 v[162:163], v50 offset:9344
  v_mfma_f32_16x16x32_bf16 v[96:99], v[192:195], v[204:207], v[96:99]
  ds_read_b64_tr_b16 v[164:165], v52 offset:6272
  v_mfma_f32_16x16x32_bf16 v[76:79], v[196:199], v[200:203], v[76:79]
  ds_read_b64_tr_b16 v[166:167], v52 offset:9344
  v_mfma_f32_16x16x32_bf16 v[100:103], v[196:199], v[204:207], v[100:103]
  s_cmp_lg_u32 s4, 3
  s_cbranch_scc1 L_C_cs7
  v_mfma_f32_16x16x32_bf16 v[120:123], v[176:179], v[24:27], v[120:123]
  v_mfma_f32_16x16x32_bf16 v[124:127], v[180:183], v[24:27], v[124:127]
  v_mfma_f32_16x16x32_bf16 v[128:131], v[184:187], v[24:27], v[128:131]
  v_mfma_f32_16x16x32_bf16 v[132:135], v[188:191], v[24:27], v[132:135]
  v_mfma_f32_16x16x32_bf16 v[136:139], v[192:195], v[24:27], v[136:139]
  v_mfma_f32_16x16x32_bf16 v[140:143], v[196:199], v[24:27], v[140:143]
L_C_cs7:
  s_waitcnt lgkmcnt(0)
  v_mfma_f32_16x16x32_bf16 v[104:107], v[24:27], v[168:171], v[104:107]
  ds_read_b128 v[200:203], v53 offset:55296
  v_mfma_f32_16x16x32_bf16 v[112:115], v[168:171], v[168:171], v[112:115]
  ds_read_b128 v[204:207], v53 offset:56320
  v_mfma_f32_16x16x32_bf16 v[108:111], v[24:27], v[172:175], v[108:111]
  ds_read_b64_tr_b16 v[176:177], v50 offset:12288
  v_mfma_f32_16x16x32_bf16 v[116:119], v[172:175], v[172:175], v[116:119]
  ds_read_b64_tr_b16 v[178:179], v50 offset:15360
  v_mfma_f32_16x16x32_bf16 v[56:59], v[144:147], v[168:171], v[56:59]
  ds_read_b64_tr_b16 v[180:181], v52 offset:12288
  v_mfma_f32_16x16x32_bf16 v[80:83], v[144:147], v[172:175], v[80:83]
  ds_read_b64_tr_b16 v[182:183], v52 offset:15360
  v_mfma_f32_16x16x32_bf16 v[60:63], v[148:151], v[168:171], v[60:63]
  ds_read_b64_tr_b16 v[184:185], v50 offset:12352
  v_mfma_f32_16x16x32_bf16 v[84:87], v[148:151], v[172:175], v[84:87]
  ds_read_b64_tr_b16 v[186:187], v50 offset:15424
  v_mfma_f32_16x16x32_bf16 v[64:67], v[152:155], v[168:171], v[64:67]
  ds_read_b64_tr_b16 v[188:189], v52 offset:12352
  v_mfma_f32_16x16x32_bf16 v[88:91], v[152:155], v[172:175], v[88:91]
  ds_read_b64_tr_b16 v[190:191], v52 offset:15424
  v_mfma_f32_16x16x32_bf16 v[68:71], v[156:159], v[168:171], v[68:71]
  ds_read_b64_tr_b16 v[192:193], v50 offset:12416
  v_mfma_f32_16x16x32_bf16 v[92:95], v[156:159], v[172:175], v[92:95]
  ds_read_b64_tr_b16 v[194:195], v50 offset:15488
  v_mfma_f32_16x16x32_bf16 v[72:75], v[160:163], v[168:171], v[72:75]
  ds_read_b64_tr_b16 v[196:197], v52 offset:12416
  v_mfma_f32_16x16x32_bf16 v[96:99], v[160:163], v[172:175], v[96:99]
  ds_read_b64_tr_b16 v[198:199], v52 offset:15488
  v_mfma_f32_16x16x32_bf16 v[76:79], v[164:167], v[168:171], v[76:79]
  v_mfma_f32_16x16x32_bf16 v[100:103], v[164:167], v[172:175], v[100:103]
  s_cmp_lg_u32 s4, 0
  s_cbranch_scc1 L_C_cs8
  v_mfma_f32_16x16x32_bf16 v[120:123], v[144:147], v[24:27], v[120:123]
  v_mfma_f32_16x16x32_bf16 v[124:127], v[148:151], v[24:27], v[124:127]
  v_mfma_f32_16x16x32_bf16 v[128:131], v[152:155], v[24:27], v[128:131]
  v_mfma_f32_16x16x32_bf16 v[132:135], v[156:159], v[24:27], v[132:135]
  v_mfma_f32_16x16x32_bf16 v[136:139], v[160:163], v[24:27], v[136:139]
  v_mfma_f32_16x16x32_bf16 v[140:143], v[164:167], v[24:27], v[140:143]
L_C_cs8:
  s_waitcnt lgkmcnt(0)
  v_mfma_f32_16x16x32_bf16 v[104:107], v[24:27], v[200:203], v[104:107]
  s_barrier
  v_mfma_f32_16x16x32_bf16 v[112:115], v[200:203], v[200:203], v[112:115]
  ds_read_b128 v[168:171], v53 offset:63488
  v_mfma_f32_16x16x32_bf16 v[108:111], v[24:27], v[204:207], v[108:111]
  ds_read_b128 v[172:175], v53 offset:64512
  v_mfma_f32_16x16x32_bf16 v[116:119], v[204:207], v[204:207], v[116:119]
  ds_read_b64_tr_b16 v[144:145], v49 offset:18432
  v_mfma_f32_16x16x32_bf16 v[56:59], v[176:179], v[200:203], v[56:59]
  ds_read_b64_tr_b16 v[146:147], v49 offset:21504
  v_mfma_f32_16x16x32_bf16 v[80:83], v[176:179], v[204:207], v[80:83]
  ds_read_b64_tr_b16 v[148:149], v51 offset:18432
  v_mfma_f32_16x16x32_bf16 v[60:63], v[180:183], v[200:203], v[60:63]
  ds_read_b64_tr_b16 v[150:151], v51 offset:21504
  v_mfma_f32_16x16x32_bf16 v[84:87], v[180:183], v[204:207], v[84:87]
  ds_read_b64_tr_b16 v[152:153], v49 offset:18496
  v_mfma_f32_16x16x32_bf16 v[64:67], v[184:187], v[200:203], v[64:67]
  ds_read_b64_tr_b16 v[154:155], v49 offset:21568
  v_mfma_f32_16x16x32_bf16 v[88:91], v[184:187], v[204:207], v[88:91]
  ds_read_b64_tr_b16 v[156:157], v51 offset:18496
  v_mfma_f32_16x16x32_bf16 v[68:71], v[188:191], v[200:203], v[68:71]
  ds_read_b64_tr_b16 v[158:159], v51 offset:21568
  v_mfma_f32_16x16x32_bf16 v[92:95], v[188:191], v[204:207], v[92:95]
  ds_read_b64_tr_b16 v[160:161], v49 offset:18560
  v_mfma_f32_16x16x32_bf16 v[72:75], v[192:195], v[200:203], v[72:75]
  ds_read_b64_tr_b16 v[162:163], v49 offset:21632
  v_mfma_f32_16x16x32_bf16 v[96:99], v[192:195], v[204:207], v[96:99]
  ds_read_b64_tr_b16 v[164:165], v51 offset:18560
  v_mfma_f32_16x16x32_bf16 v[76:79], v[196:199], v[200:203], v[76:79]
  ds_read_b64_tr_b16 v[166:167], v51 offset:21632
  v_mfma_f32_16x16x32_bf16 v[100:103], v[196:199], v[204:207], v[100:103]
  s_cmp_lg_u32 s4, 1
  s_cbranch_scc1 L_C_cs9
  v_mfma_f32_16x16x32_bf16 v[120:123], v[176:179], v[24:27], v[120:123]
  v_mfma_f32_16x16x32_bf16 v[124:127], v[180:183], v[24:27], v[124:127]
  v_mfma_f32_16x16x32_bf16 v[128:131], v[184:187], v[24:27], v[128:131]
  v_mfma_f32_16x16x32_bf16 v[132:135], v[188:191], v[24:27], v[132:135]
  v_mfma_f32_16x16x32_bf16 v[136:139], v[192:195], v[24:27], v[136:139]
  v_mfma_f32_16x16x32_bf16 v[140:143], v[196:199], v[24:27], v[140:143]
L_C_cs9:
  s_waitcnt lgkmcnt(0)
  v_mfma_f32_16x16x32_bf16 v[104:107], v[24:27], v[168:171], v[104:107]
  ds_read_b128 v[200:203], v48 offset:16384
  v_mfma_f32_16x16x32_bf16 v[112:115], v[168:171], v[168:171], v[112:115]
  ds_read_b128 v[204:207], v48 offset:17408
  v_mfma_f32_16x16x32_bf16 v[108:111], v[24:27], v[172:175], v[108:111]
  ds_read_b64_tr_b16 v[176:177], v49 offset:24576
  v_mfma_f32_16x16x32_bf16 v[116:119], v[172:175], v[172:175], v[116:119]
  ds_read_b64_tr_b16 v[178:179], v49 offset:27648
  v_mfma_f32_16x16x32_bf16 v[56:59], v[144:147], v[168:171], v[56:59]
  ds_read_b64_tr_b16 v[180:181], v51 offset:24576
  v_mfma_f32_16x16x32_bf16 v[80:83], v[144:147], v[172:175], v[80:83]
  ds_read_b64_tr_b16 v[182:183], v51 offset:27648
  v_mfma_f32_16x16x32_bf16 v[60:63], v[148:151], v[168:171], v[60:63]
  ds_read_b64_tr_b16 v[184:185], v49 offset:24640
  v_mfma_f32_16x16x32_bf16 v[84:87], v[148:151], v[172:175], v[84:87]
  ds_read_b64_tr_b16 v[186:187], v49 offset:27712
  v_mfma_f32_16x16x32_bf16 v[64:67], v[152:155], v[168:171], v[64:67]
  ds_read_b64_tr_b16 v[188:189], v51 offset:24640
  v_mfma_f32_16x16x32_bf16 v[88:91], v[152:155], v[172:175], v[88:91]
  ds_read_b64_tr_b16 v[190:191], v51 offset:27712
  v_mfma_f32_16x16x32_bf16 v[68:71], v[156:159], v[168:171], v[68:71]
  ds_read_b64_tr_b16 v[192:193], v49 offset:24704
  v_mfma_f32_16x16x32_bf16 v[92:95], v[156:159], v[172:175], v[92:95]
  ds_read_b64_tr_b16 v[194:195], v49 offset:27776
  v_mfma_f32_16x16x32_bf16 v[72:75], v[160:163], v[168:171], v[72:75]
  ds_read_b64_tr_b16 v[196:197], v51 offset:24704
  v_mfma_f32_16x16x32_bf16 v[96:99], v[160:163], v[172:175], v[96:99]
  ds_read_b64_tr_b16 v[198:199], v51 offset:27776
  v_mfma_f32_16x16x32_bf16 v[76:79], v[164:167], v[168:171], v[76:79]
  v_mfma_f32_16x16x32_bf16 v[100:103], v[164:167], v[172:175], v[100:103]
  s_cmp_lg_u32 s4, 2
  s_cbranch_scc1 L_C_cs10
  v_mfma_f32_16x16x32_bf16 v[120:123], v[144:147], v[24:27], v[120:123]
  v_mfma_f32_16x16x32_bf16 v[124:127], v[148:151], v[24:27], v[124:127]
  v_mfma_f32_16x16x32_bf16 v[128:131], v[152:155], v[24:27], v[128:131]
  v_mfma_f32_16x16x32_bf16 v[132:135], v[156:159], v[24:27], v[132:135]
  v_mfma_f32_16x16x32_bf16 v[136:139], v[160:163], v[24:27], v[136:139]
  v_mfma_f32_16x16x32_bf16 v[140:143], v[164:167], v[24:27], v[140:143]
L_C_cs10:
  s_waitcnt lgkmcnt(0)
  v_mfma_f32_16x16x32_bf16 v[104:107], v[24:27], v[200:203], v[104:107]
  s_barrier
  v_mfma_f32_16x16x32_bf16 v[112:115], v[200:203], v[200:203], v[112:115]
  ds_read_b128 v[168:171], v48 offset:24576
  v_mfma_f32_16x16x32_bf16 v[108:111], v[24:27], v[204:207], v[108:111]
  ds_read_b128 v[172:175], v48 offset:25600
  v_mfma_f32_16x16x32_bf16 v[116:119], v[204:207], v[204:207], v[116:119]
  ds_read_b64_tr_b16 v[144:145], v49 offset:6144
  v_mfma_f32_16x16x32_bf16 v[56:59], v[176:179], v[200:203], v[56:59]
  ds_read_b64_tr_b16 v[146:147], v49 offset:9216
  v_mfma_f32_16x16x32_bf16 v[80:83], v[176:179], v[204:207], v[80:83]
  ds_read_b64_tr_b16 v[148:149], v51 offset:6144
  v_mfma_f32_16x16x32_bf16 v[60:63], v[180:183], v[200:203], v[60:63]
  ds_read_b64_tr_b16 v[150:151], v51 offset:9216
  v_mfma_f32_16x16x32_bf16 v[84:87], v[180:183], v[204:207], v[84:87]
  ds_read_b64_tr_b16 v[152:153], v49 offset:6208
  v_mfma_f32_16x16x32_bf16 v[64:67], v[184:187], v[200:203], v[64:67]
  ds_read_b64_tr_b16 v[154:155], v49 offset:9280
  v_mfma_f32_16x16x32_bf16 v[88:91], v[184:187], v[204:207], v[88:91]
  ds_read_b64_tr_b16 v[156:157], v51 offset:6208
  v_mfma_f32_16x16x32_bf16 v[68:71], v[188:191], v[200:203], v[68:71]
  ds_read_b64_tr_b16 v[158:159], v51 offset:9280
  v_mfma_f32_16x16x32_bf16 v[92:95], v[188:191], v[204:207], v[92:95]
  ds_read_b64_tr_b16 v[160:161], v49 offset:6272
  v_mfma_f32_16x16x32_bf16 v[72:75], v[192:195], v[200:203], v[72:75]
  ds_read_b64_tr_b16 v[162:163], v49 offset:9344
  v_mfma_f32_16x16x32_bf16 v[96:99], v[192:195], v[204:207], v[96:99]
  ds_read_b64_tr_b16 v[164:165], v51 offset:6272
  v_mfma_f32_16x16x32_bf16 v[76:79], v[196:199], v[200:203], v[76:79]
  ds_read_b64_tr_b16 v[166:167], v51 offset:9344
  v_mfma_f32_16x16x32_bf16 v[100:103], v[196:199], v[204:207], v[100:103]
  s_cmp_lg_u32 s4, 3
  s_cbranch_scc1 L_C_cs11
  v_mfma_f32_16x16x32_bf16 v[120:123], v[176:179], v[24:27], v[120:123]
  v_mfma_f32_16x16x32_bf16 v[124:127], v[180:183], v[24:27], v[124:127]
  v_mfma_f32_16x16x32_bf16 v[128:131], v[184:187], v[24:27], v[128:131]
  v_mfma_f32_16x16x32_bf16 v[132:135], v[188:191], v[24:27], v[132:135]
  v_mfma_f32_16x16x32_bf16 v[136:139], v[192:195], v[24:27], v[136:139]
  v_mfma_f32_16x16x32_bf16 v[140:143], v[196:199], v[24:27], v[140:143]
L_C_cs11:
  s_waitcnt lgkmcnt(0)
  v_mfma_f32_16x16x32_bf16 v[104:107], v[24:27], v[168:171], v[104:107]
  ds_read_b128 v[200:203], v48 offset:32768
  v_mfma_f32_16x16x32_bf16 v[112:115], v[168:171], v[168:171], v[112:115]
  ds_read_b128 v[204:207], v48 offset:33792
  v_mfma_f32_16x16x32_bf16 v[108:111], v[24:27], v[172:175], v[108:111]
  ds_read_b64_tr_b16 v[176:177], v49 offset:12288
  v_mfma_f32_16x16x32_bf16 v[116:119], v[172:175], v[172:175], v[116:119]
  ds_read_b64_tr_b16 v[178:179], v49 offset:15360
  v_mfma_f32_16x16x32_bf16 v[56:59], v[144:147], v[168:171], v[56:59]
  ds_read_b64_tr_b16 v[180:181], v51 offset:12288
  v_mfma_f32_16x16x32_bf16 v[80:83], v[144:147], v[172:175], v[80:83]
  ds_read_b64_tr_b16 v[182:183], v51 offset:15360
  v_mfma_f32_16x16x32_bf16 v[60:63], v[148:151], v[168:171], v[60:63]
  ds_read_b64_tr_b16 v[184:185], v49 offset:12352
  v_mfma_f32_16x16x32_bf16 v[84:87], v[148:151], v[172:175], v[84:87]
  ds_read_b64_tr_b16 v[186:187], v49 offset:15424
  v_mfma_f32_16x16x32_bf16 v[64:67], v[152:155], v[168:171], v[64:67]
  ds_read_b64_tr_b16 v[188:189], v51 offset:12352
  v_mfma_f32_16x16x32_bf16 v[88:91], v[152:155], v[172:175], v[88:91]
  ds_read_b64_tr_b16 v[190:191], v51 offset:15424
  v_mfma_f32_16x16x32_bf16 v[68:71], v[156:159], v[168:171], v[68:71]
  ds_read_b64_tr_b16 v[192:193], v49 offset:12416
  v_mfma_f32_16x16x32_bf16 v[92:95], v[156:159], v[172:175], v[92:95]
  ds_read_b64_tr_b16 v[194:195], v49 offset:15488
  v_mfma_f32_16x16x32_bf16 v[72:75], v[160:163], v[168:171], v[72:75]
  ds_read_b64_tr_b16 v[196:197], v51 offset:12416
  v_mfma_f32_16x16x32_bf16 v[96:99], v[160:163], v[172:175], v[96:99]
  ds_read_b64_tr_b16 v[198:199], v51 offset:15488
  v_mfma_f32_16x16x32_bf16 v[76:79], v[164:167], v[168:171], v[76:79]
  v_mfma_f32_16x16x32_bf16 v[100:103], v[164:167], v[172:175], v[100:103]
  s_cmp_lg_u32 s4, 0
  s_cbranch_scc1 L_C_cs12
  v_mfma_f32_16x16x32_bf16 v[120:123], v[144:147], v[24:27], v[120:123]
  v_mfma_f32_16x16x32_bf16 v[124:127], v[148:151], v[24:27], v[124:127]
  v_mfma_f32_16x16x32_bf16 v[128:131], v[152:155], v[24:27], v[128:131]
  v_mfma_f32_16x16x32_bf16 v[132:135], v[156:159], v[24:27], v[132:135]
  v_mfma_f32_16x16x32_bf16 v[136:139], v[160:163], v[24:27], v[136:139]
  v_mfma_f32_16x16x32_bf16 v[140:143], v[164:167], v[24:27], v[140:143]
L_C_cs12:
  s_waitcnt lgkmcnt(0)
  v_mfma_f32_16x16x32_bf16 v[104:107], v[24:27], v[200:203], v[104:107]
  s_barrier
  v_mfma_f32_16x16x32_bf16 v[112:115], v[200:203], v[200:203], v[112:115]
  ds_read_b128 v[168:171], v48 offset:40960
  v_mfma_f32_16x16x32_bf16 v[108:111], v[24:27], v[204:207], v[108:111]
  ds_read_b128 v[172:175], v48 offset:41984
  v_mfma_f32_16x16x32_bf16 v[116:119], v[204:207], v[204:207], v[116:119]
  ds_read_b64_tr_b16 v[144:145], v50 offset:18432
  v_mfma_f32_16x16x32_bf16 v[56:59], v[176:179], v[200:203], v[56:59]
  ds_read_b64_tr_b16 v[146:147], v50 offset:21504
  v_mfma_f32_16x16x32_bf16 v[80:83], v[176:179], v[204:207], v[80:83]
  ds_read_b64_tr_b16 v[148:149], v52 offset:18432
  v_mfma_f32_16x16x32_bf16 v[60:63], v[180:183], v[200:203], v[60:63]
  ds_read_b64_tr_b16 v[150:151], v52 offset:21504
  v_mfma_f32_16x16x32_bf16 v[84:87], v[180:183], v[204:207], v[84:87]
  ds_read_b64_tr_b16 v[152:153], v50 offset:18496
  v_mfma_f32_16x16x32_bf16 v[64:67], v[184:187], v[200:203], v[64:67]
  ds_read_b64_tr_b16 v[154:155], v50 offset:21568
  v_mfma_f32_16x16x32_bf16 v[88:91], v[184:187], v[204:207], v[88:91]
  ds_read_b64_tr_b16 v[156:157], v52 offset:18496
  v_mfma_f32_16x16x32_bf16 v[68:71], v[188:191], v[200:203], v[68:71]
  ds_read_b64_tr_b16 v[158:159], v52 offset:21568
  v_mfma_f32_16x16x32_bf16 v[92:95], v[188:191], v[204:207], v[92:95]
  ds_read_b64_tr_b16 v[160:161], v50 offset:18560
  v_mfma_f32_16x16x32_bf16 v[72:75], v[192:195], v[200:203], v[72:75]
  ds_read_b64_tr_b16 v[162:163], v50 offset:21632
  v_mfma_f32_16x16x32_bf16 v[96:99], v[192:195], v[204:207], v[96:99]
  ds_read_b64_tr_b16 v[164:165], v52 offset:18560
  v_mfma_f32_16x16x32_bf16 v[76:79], v[196:199], v[200:203], v[76:79]
  ds_read_b64_tr_b16 v[166:167], v52 offset:21632
  v_mfma_f32_16x16x32_bf16 v[100:103], v[196:199], v[204:207], v[100:103]
  s_cmp_lg_u32 s4, 1
  s_cbranch_scc1 L_C_cs13
  v_mfma_f32_16x16x32_bf16 v[120:123], v[176:179], v[24:27], v[120:123]
  v_mfma_f32_16x16x32_bf16 v[124:127], v[180:183], v[24:27], v[124:127]
  v_mfma_f32_16x16x32_bf16 v[128:131], v[184:187], v[24:27], v[128:131]
  v_mfma_f32_16x16x32_bf16 v[132:135], v[188:191], v[24:27], v[132:135]
  v_mfma_f32_16x16x32_bf16 v[136:139], v[192:195], v[24:27], v[136:139]
  v_mfma_f32_16x16x32_bf16 v[140:143], v[196:199], v[24:27], v[140:143]
L_C_cs13:
  s_waitcnt lgkmcnt(0)
  v_mfma_f32_16x16x32_bf16 v[104:107], v[24:27], v[168:171], v[104:107]
  ds_read_b128 v[200:203], v48 offset:49152
  v_mfma_f32_16x16x32_bf16 v[112:115], v[168:171], v[168:171], v[112:115]
  ds_read_b128 v[204:207], v48 offset:50176
  s_lshl_b32 s62, s5, 11
  s_add_u32 s62, s62, 9963008
  s_lshl_b32 s55, s6, 4
  s_add_u32 s54, s62, s55
  s_lshl_b32 s55, s4, 2
  s_add_u32 s54, s54, s55
  s_and_b32 s55, s6, 16
  s_lshl_b32 s55, s55, 4
  s_add_u32 s62, s62, s55
  v_mov_b32 v208, 0
  s_mov_b64 exec, 1
  buffer_store_dword v36, v208, s[36:39], s54 offen
  s_mov_b64 exec, -1
  v_lshlrev_b32 v208, 2, v2
  v_mfma_f32_16x16x32_bf16 v[108:111], v[24:27], v[172:175], v[108:111]
  ds_read_b64_tr_b16 v[176:177], v50 offset:24576
  v_mfma_f32_16x16x32_bf16 v[116:119], v[172:175], v[172:175], v[116:119]
  ds_read_b64_tr_b16 v[178:179], v50 offset:27648
  v_mfma_f32_16x16x32_bf16 v[56:59], v[144:147], v[168:171], v[56:59]
  ds_read_b64_tr_b16 v[180:181], v52 offset:24576
  v_mfma_f32_16x16x32_bf16 v[80:83], v[144:147], v[172:175], v[80:83]
  ds_read_b64_tr_b16 v[182:183], v52 offset:27648
  v_mfma_f32_16x16x32_bf16 v[60:63], v[148:151], v[168:171], v[60:63]
  ds_read_b64_tr_b16 v[184:185], v50 offset:24640
  v_mfma_f32_16x16x32_bf16 v[84:87], v[148:151], v[172:175], v[84:87]
  ds_read_b64_tr_b16 v[186:187], v50 offset:27712
  v_mfma_f32_16x16x32_bf16 v[64:67], v[152:155], v[168:171], v[64:67]
  ds_read_b64_tr_b16 v[188:189], v52 offset:24640
  v_mfma_f32_16x16x32_bf16 v[88:91], v[152:155], v[172:175], v[88:91]
  ds_read_b64_tr_b16 v[190:191], v52 offset:27712
  v_mfma_f32_16x16x32_bf16 v[68:71], v[156:159], v[168:171], v[68:71]
  ds_read_b64_tr_b16 v[192:193], v50 offset:24704
  v_mfma_f32_16x16x32_bf16 v[92:95], v[156:159], v[172:175], v[92:95]
  ds_read_b64_tr_b16 v[194:195], v50 offset:27776
  v_mfma_f32_16x16x32_bf16 v[72:75], v[160:163], v[168:171], v[72:75]
  ds_read_b64_tr_b16 v[196:197], v52 offset:24704
  v_mfma_f32_16x16x32_bf16 v[96:99], v[160:163], v[172:175], v[96:99]
  ds_read_b64_tr_b16 v[198:199], v52 offset:27776
  v_mfma_f32_16x16x32_bf16 v[76:79], v[164:167], v[168:171], v[76:79]
  v_mfma_f32_16x16x32_bf16 v[100:103], v[164:167], v[172:175], v[100:103]
  s_cmp_lg_u32 s4, 2
  s_cbranch_scc1 L_C_cs14
  v_mfma_f32_16x16x32_bf16 v[120:123], v[144:147], v[24:27], v[120:123]
  v_mfma_f32_16x16x32_bf16 v[124:127], v[148:151], v[24:27], v[124:127]
  v_mfma_f32_16x16x32_bf16 v[128:131], v[152:155], v[24:27], v[128:131]
  v_mfma_f32_16x16x32_bf16 v[132:135], v[156:159], v[24:27], v[132:135]
  v_mfma_f32_16x16x32_bf16 v[136:139], v[160:163], v[24:27], v[136:139]
  v_mfma_f32_16x16x32_bf16 v[140:143], v[164:167], v[24:27], v[140:143]
L_C_cs14:
  s_waitcnt lgkmcnt(0)
  v_mfma_f32_16x16x32_bf16 v[104:107], v[24:27], v[200:203], v[104:107]
  v_mfma_f32_16x16x32_bf16 v[112:115], v[200:203], v[200:203], v[112:115]
  v_mfma_f32_16x16x32_bf16 v[108:111], v[24:27], v[204:207], v[108:111]
  v_mfma_f32_16x16x32_bf16 v[116:119], v[204:207], v[204:207], v[116:119]
  v_mfma_f32_16x16x32_bf16 v[56:59], v[176:179], v[200:203], v[56:59]
  v_mfma_f32_16x16x32_bf16 v[80:83], v[176:179], v[204:207], v[80:83]
  v_mfma_f32_16x16x32_bf16 v[60:63], v[180:183], v[200:203], v[60:63]
  v_mfma_f32_16x16x32_bf16 v[84:87], v[180:183], v[204:207], v[84:87]
  v_mfma_f32_16x16x32_bf16 v[64:67], v[184:187], v[200:203], v[64:67]
  v_mfma_f32_16x16x32_bf16 v[88:91], v[184:187], v[204:207], v[88:91]
  v_mfma_f32_16x16x32_bf16 v[68:71], v[188:191], v[200:203], v[68:71]
  v_mfma_f32_16x16x32_bf16 v[92:95], v[188:191], v[204:207], v[92:95]
  v_mfma_f32_16x16x32_bf16 v[72:75], v[192:195], v[200:203], v[72:75]
  v_mfma_f32_16x16x32_bf16 v[96:99], v[192:195], v[204:207], v[96:99]
  v_mfma_f32_16x16x32_bf16 v[76:79], v[196:199], v[200:203], v[76:79]
  v_mfma_f32_16x16x32_bf16 v[100:103], v[196:199], v[204:207], v[100:103]
  s_cmp_lg_u32 s4, 3
  s_cbranch_scc1 L_C_cs15
  v_mfma_f32_16x16x32_bf16 v[120:123], v[176:179], v[24:27], v[120:123]
  v_mfma_f32_16x16x32_bf16 v[124:127], v[180:183], v[24:27], v[124:127]
  v_mfma_f32_16x16x32_bf16 v[128:131], v[184:187], v[24:27], v[128:131]
  v_mfma_f32_16x16x32_bf16 v[132:135], v[188:191], v[24:27], v[132:135]
  v_mfma_f32_16x16x32_bf16 v[136:139], v[192:195], v[24:27], v[136:139]
  v_mfma_f32_16x16x32_bf16 v[140:143], v[196:199], v[24:27], v[140:143]
L_C_cs15:
  s_nop 7
  buffer_load_dword v209, v208, s[36:39], s62 offen sc1
  v_lshlrev_b32 v6, 4, v4
  v_add_u32 v6, 161792, v6
  s_mul_i32 s53, s4, 448
  v_add_u32 v10, s53, v6
  v_and_b32 v11, 3, v3
  v_mul_u32_u24 v11, 448, v11
  v_add_u32 v6, v11, v6
  s_mov_b64 exec, s[60:61]
  ds_write_b128 v10, v[120:123] offset:0
  ds_write_b128 v10, v[124:127] offset:64
  ds_write_b128 v10, v[128:131] offset:128
  ds_write_b128 v10, v[132:135] offset:192
  ds_write_b128 v10, v[136:139] offset:256
  ds_write_b128 v10, v[140:143] offset:320
  s_mov_b64 exec, -1
  v_cndmask_b32 v7, v112, v113, s[44:45]
  v_cndmask_b32 v7, v7, v114, s[46:47]
  v_cndmask_b32 v7, v7, v115, s[48:49]
  v_cndmask_b32 v7, 0, v7, s[50:51]
  v_mov_b32 v214, v7
  s_nop 1
  v_permlane16_swap_b32 v7, v214
  v_add_f32 v7, v7, v214
  v_mov_b32 v214, v7
  s_nop 1
  v_permlane32_swap_b32 v7, v214
  v_add_f32 v7, v7, v214
  v_mul_f32 v8, 0x3b000000, v104
  v_mul_f32 v9, 0x3b000000, v7
  v_fma_f32 v9, -v8, v8, v9
  v_max_f32 v9, 0, v9
  v_cvt_pk_bf16_f32 v210, v8, v8
  v_lshlrev_b32 v210, 16, v210
  v_cvt_pk_bf16_f32 v9, v9, v9
  v_lshlrev_b32 v9, 16, v9
  v_add_f32 v9, 0x3727c5ac, v9
  v_cvt_pk_bf16_f32 v9, v9, v9
  v_lshlrev_b32 v9, 16, v9
  v_sqrt_f32 v9, v9
  s_nop 0
  v_cvt_pk_bf16_f32 v9, v9, v9
  v_lshlrev_b32 v9, 16, v9
  v_rcp_f32 v211, v9
  v_cndmask_b32 v7, v116, v117, s[44:45]
  v_cndmask_b32 v7, v7, v118, s[46:47]
  v_cndmask_b32 v7, v7, v119, s[48:49]
  v_cndmask_b32 v7, 0, v7, s[50:51]
  v_mov_b32 v214, v7
  s_nop 1
  v_permlane16_swap_b32 v7, v214
  v_add_f32 v7, v7, v214
  v_mov_b32 v214, v7
  s_nop 1
  v_permlane32_swap_b32 v7, v214
  v_add_f32 v7, v7, v214
  v_mul_f32 v8, 0x3b000000, v108
  v_mul_f32 v9, 0x3b000000, v7
  v_fma_f32 v9, -v8, v8, v9
  v_max_f32 v9, 0, v9
  v_cvt_pk_bf16_f32 v212, v8, v8
  v_lshlrev_b32 v212, 16, v212
  v_cvt_pk_bf16_f32 v9, v9, v9
  v_lshlrev_b32 v9, 16, v9
  v_add_f32 v9, 0x3727c5ac, v9
  v_cvt_pk_bf16_f32 v9, v9, v9
  v_lshlrev_b32 v9, 16, v9
  v_sqrt_f32 v9, v9
  s_nop 0
  v_cvt_pk_bf16_f32 v9, v9, v9
  v_lshlrev_b32 v9, 16, v9
  v_rcp_f32 v213, v9
  s_waitcnt lgkmcnt(0)
  s_barrier
  s_cmp_eq_u32 s43, 15
  s_cbranch_scc1 L_C_SKIPC
  ds_read_b128 v[120:123], v6 offset:0
  ds_read_b128 v[124:127], v6 offset:64
  ds_read_b128 v[128:131], v6 offset:128
  ds_read_b128 v[132:135], v6 offset:192
  ds_read_b128 v[136:139], v6 offset:256
  ds_read_b128 v[140:143], v6 offset:320
  s_lshl_b32 s53, s42, 3
  s_lshl_b32 s54, s4, 1
  s_add_u32 s53, s53, s54
  s_mul_i32 s53, s53, 44032
  s_mul_i32 s54, s43, 3072
  s_add_u32 s53, s53, s54
  s_add_u32 s58, s53, 4194304
  s_add_u32 s59, s53, 4238336
  s_waitcnt lgkmcnt(4)
  v_add_f32_dpp v120, v120, v120 quad_perm:[1,0,3,2] row_mask:0xf bank_mask:0xf
  v_add_f32_dpp v121, v121, v121 quad_perm:[1,0,3,2] row_mask:0xf bank_mask:0xf
  v_add_f32_dpp v122, v122, v122 quad_perm:[1,0,3,2] row_mask:0xf bank_mask:0xf
  v_add_f32_dpp v123, v123, v123 quad_perm:[1,0,3,2] row_mask:0xf bank_mask:0xf
  v_add_f32_dpp v124, v124, v124 quad_perm:[1,0,3,2] row_mask:0xf bank_mask:0xf
  v_add_f32_dpp v125, v125, v125 quad_perm:[1,0,3,2] row_mask:0xf bank_mask:0xf
  v_add_f32_dpp v126, v126, v126 quad_perm:[1,0,3,2] row_mask:0xf bank_mask:0xf
  v_add_f32_dpp v127, v127, v127 quad_perm:[1,0,3,2] row_mask:0xf bank_mask:0xf
  v_add_f32_dpp v120, v120, v120 quad_perm:[2,3,0,1] row_mask:0xf bank_mask:0xf
  v_add_f32_dpp v121, v121, v121 quad_perm:[2,3,0,1] row_mask:0xf bank_mask:0xf
  v_add_f32_dpp v122, v122, v122 quad_perm:[2,3,0,1] row_mask:0xf bank_mask:0xf
  v_add_f32_dpp v123, v123, v123 quad_perm:[2,3,0,1] row_mask:0xf bank_mask:0xf
  v_add_f32_dpp v124, v124, v124 quad_perm:[2,3,0,1] row_mask:0xf bank_mask:0xf
  v_add_f32_dpp v125, v125, v125 quad_perm:[2,3,0,1] row_mask:0xf bank_mask:0xf
  v_add_f32_dpp v126, v126, v126 quad_perm:[2,3,0,1] row_mask:0xf bank_mask:0xf
  v_add_f32_dpp v127, v127, v127 quad_perm:[2,3,0,1] row_mask:0xf bank_mask:0xf
  v_pk_fma_f32 v[56:57], v[210:211], v[120:121], v[56:57] op_sel_hi:[0,1,1] neg_lo:[1,0,0] neg_hi:[1,0,0]
  v_pk_fma_f32 v[58:59], v[210:211], v[122:123], v[58:59] op_sel_hi:[0,1,1] neg_lo:[1,0,0] neg_hi:[1,0,0]
  v_pk_mul_f32 v[56:57], v[210:211], v[56:57] op_sel:[1,0] op_sel_hi:[1,1]
  v_pk_mul_f32 v[58:59], v[210:211], v[58:59] op_sel:[1,0] op_sel_hi:[1,1]
  v_cvt_pk_bf16_f32 v56, v56, v57
  v_cvt_pk_bf16_f32 v57, v58, v59
  v_pk_max_i16 v216, v56, 0
  v_pk_max_i16 v217, v57, 0
  v_pk_fma_f32 v[60:61], v[210:211], v[124:125], v[60:61] op_sel_hi:[0,1,1] neg_lo:[1,0,0] neg_hi:[1,0,0]
  v_pk_fma_f32 v[62:63], v[210:211], v[126:127], v[62:63] op_sel_hi:[0,1,1] neg_lo:[1,0,0] neg_hi:[1,0,0]
  v_pk_mul_f32 v[60:61], v[210:211], v[60:61] op_sel:[1,0] op_sel_hi:[1,1]
  v_pk_mul_f32 v[62:63], v[210:211], v[62:63] op_sel:[1,0] op_sel_hi:[1,1]
  v_cvt_pk_bf16_f32 v60, v60, v61
  v_cvt_pk_bf16_f32 v61, v62, v63
  v_pk_max_i16 v218, v60, 0
  v_pk_max_i16 v219, v61, 0
  s_mov_b32 s63, 0
L_C_HP:
  s_waitcnt vmcnt(0)
  v_cmp_ne_u32 vcc, 1, v209
  s_cbranch_vccz L_C_HP_OK
  s_add_u32 s63, s63, 1
  s_cmp_gt_u32 s63, 20000
  s_cbranch_scc1 L_C_HP_OK
  buffer_load_dword v209, v208, s[36:39], s62 offen sc1
  s_branch L_C_HP
L_C_HP_OK:
  buffer_store_dwordx4 v[216:219], v5, s[36:39], s58 offen
  v_pk_fma_f32 v[80:81], v[212:213], v[120:121], v[80:81] op_sel_hi:[0,1,1] neg_lo:[1,0,0] neg_hi:[1,0,0]
  v_pk_fma_f32 v[82:83], v[212:213], v[122:123], v[82:83] op_sel_hi:[0,1,1] neg_lo:[1,0,0] neg_hi:[1,0,0]
  v_pk_mul_f32 v[80:81], v[212:213], v[80:81] op_sel:[1,0] op_sel_hi:[1,1]
  v_pk_mul_f32 v[82:83], v[212:213], v[82:83] op_sel:[1,0] op_sel_hi:[1,1]
  v_cvt_pk_bf16_f32 v80, v80, v81
  v_cvt_pk_bf16_f32 v81, v82, v83
  v_pk_max_i16 v220, v80, 0
  v_pk_max_i16 v221, v81, 0
  v_pk_fma_f32 v[84:85], v[212:213], v[124:125], v[84:85] op_sel_hi:[0,1,1] neg_lo:[1,0,0] neg_hi:[1,0,0]
  v_pk_fma_f32 v[86:87], v[212:213], v[126:127], v[86:87] op_sel_hi:[0,1,1] neg_lo:[1,0,0] neg_hi:[1,0,0]
  v_pk_mul_f32 v[84:85], v[212:213], v[84:85] op_sel:[1,0] op_sel_hi:[1,1]
  v_pk_mul_f32 v[86:87], v[212:213], v[86:87] op_sel:[1,0] op_sel_hi:[1,1]
  v_cvt_pk_bf16_f32 v84, v84, v85
  v_cvt_pk_bf16_f32 v85, v86, v87
  v_pk_max_i16 v222, v84, 0
  v_pk_max_i16 v223, v85, 0
  buffer_store_dwordx4 v[220:223], v5, s[36:39], s59 offen
  s_cmp_eq_u32 s43, 14
  s_cbranch_scc1 L_C_CST
  s_waitcnt lgkmcnt(2)
  v_add_f32_dpp v128, v128, v128 quad_perm:[1,0,3,2] row_mask:0xf bank_mask:0xf
  v_add_f32_dpp v129, v129, v129 quad_perm:[1,0,3,2] row_mask:0xf bank_mask:0xf
  v_add_f32_dpp v130, v130, v130 quad_perm:[1,0,3,2] row_mask:0xf bank_mask:0xf
  v_add_f32_dpp v131, v131, v131 quad_perm:[1,0,3,2] row_mask:0xf bank_mask:0xf
  v_add_f32_dpp v132, v132, v132 quad_perm:[1,0,3,2] row_mask:0xf bank_mask:0xf
  v_add_f32_dpp v133, v133, v133 quad_perm:[1,0,3,2] row_mask:0xf bank_mask:0xf
  v_add_f32_dpp v134, v134, v134 quad_perm:[1,0,3,2] row_mask:0xf bank_mask:0xf
  v_add_f32_dpp v135, v135, v135 quad_perm:[1,0,3,2] row_mask:0xf bank_mask:0xf
  v_add_f32_dpp v128, v128, v128 quad_perm:[2,3,0,1] row_mask:0xf bank_mask:0xf
  v_add_f32_dpp v129, v129, v129 quad_perm:[2,3,0,1] row_mask:0xf bank_mask:0xf
  v_add_f32_dpp v130, v130, v130 quad_perm:[2,3,0,1] row_mask:0xf bank_mask:0xf
  v_add_f32_dpp v131, v131, v131 quad_perm:[2,3,0,1] row_mask:0xf bank_mask:0xf
  v_add_f32_dpp v132, v132, v132 quad_perm:[2,3,0,1] row_mask:0xf bank_mask:0xf
  v_add_f32_dpp v133, v133, v133 quad_perm:[2,3,0,1] row_mask:0xf bank_mask:0xf
  v_add_f32_dpp v134, v134, v134 quad_perm:[2,3,0,1] row_mask:0xf bank_mask:0xf
  v_add_f32_dpp v135, v135, v135 quad_perm:[2,3,0,1] row_mask:0xf bank_mask:0xf
  v_pk_fma_f32 v[64:65], v[210:211], v[128:129], v[64:65] op_sel_hi:[0,1,1] neg_lo:[1,0,0] neg_hi:[1,0,0]
  v_pk_fma_f32 v[66:67], v[210:211], v[130:131], v[66:67] op_sel_hi:[0,1,1] neg_lo:[1,0,0] neg_hi:[1,0,0]
  v_pk_mul_f32 v[64:65], v[210:211], v[64:65] op_sel:[1,0] op_sel_hi:[1,1]
  v_pk_mul_f32 v[66:67], v[210:211], v[66:67] op_sel:[1,0] op_sel_hi:[1,1]
  v_cvt_pk_bf16_f32 v64, v64, v65
  v_cvt_pk_bf16_f32 v65, v66, v67
  v_pk_max_i16 v216, v64, 0
  v_pk_max_i16 v217, v65, 0
  v_pk_fma_f32 v[68:69], v[210:211], v[132:133], v[68:69] op_sel_hi:[0,1,1] neg_lo:[1,0,0] neg_hi:[1,0,0]
  v_pk_fma_f32 v[70:71], v[210:211], v[134:135], v[70:71] op_sel_hi:[0,1,1] neg_lo:[1,0,0] neg_hi:[1,0,0]
  v_pk_mul_f32 v[68:69], v[210:211], v[68:69] op_sel:[1,0] op_sel_hi:[1,1]
  v_pk_mul_f32 v[70:71], v[210:211], v[70:71] op_sel:[1,0] op_sel_hi:[1,1]
  v_cvt_pk_bf16_f32 v68, v68, v69
  v_cvt_pk_bf16_f32 v69, v70, v71
  v_pk_max_i16 v218, v68, 0
  v_pk_max_i16 v219, v69, 0
  buffer_store_dwordx4 v[216:219], v5, s[36:39], s58 offen offset:1024
  v_pk_fma_f32 v[88:89], v[212:213], v[128:129], v[88:89] op_sel_hi:[0,1,1] neg_lo:[1,0,0] neg_hi:[1,0,0]
  v_pk_fma_f32 v[90:91], v[212:213], v[130:131], v[90:91] op_sel_hi:[0,1,1] neg_lo:[1,0,0] neg_hi:[1,0,0]
  v_pk_mul_f32 v[88:89], v[212:213], v[88:89] op_sel:[1,0] op_sel_hi:[1,1]
  v_pk_mul_f32 v[90:91], v[212:213], v[90:91] op_sel:[1,0] op_sel_hi:[1,1]
  v_cvt_pk_bf16_f32 v88, v88, v89
  v_cvt_pk_bf16_f32 v89, v90, v91
  v_pk_max_i16 v220, v88, 0
  v_pk_max_i16 v221, v89, 0
  v_pk_fma_f32 v[92:93], v[212:213], v[132:133], v[92:93] op_sel_hi:[0,1,1] neg_lo:[1,0,0] neg_hi:[1,0,0]
  v_pk_fma_f32 v[94:95], v[212:213], v[134:135], v[94:95] op_sel_hi:[0,1,1] neg_lo:[1,0,0] neg_hi:[1,0,0]
  v_pk_mul_f32 v[92:93], v[212:213], v[92:93] op_sel:[1,0] op_sel_hi:[1,1]
  v_pk_mul_f32 v[94:95], v[212:213], v[94:95] op_sel:[1,0] op_sel_hi:[1,1]
  v_cvt_pk_bf16_f32 v92, v92, v93
  v_cvt_pk_bf16_f32 v93, v94, v95
  v_pk_max_i16 v222, v92, 0
  v_pk_max_i16 v223, v93, 0
  buffer_store_dwordx4 v[220:223], v5, s[36:39], s59 offen offset:1024
  s_waitcnt lgkmcnt(0)
  v_add_f32_dpp v136, v136, v136 quad_perm:[1,0,3,2] row_mask:0xf bank_mask:0xf
  v_add_f32_dpp v137, v137, v137 quad_perm:[1,0,3,2] row_mask:0xf bank_mask:0xf
  v_add_f32_dpp v138, v138, v138 quad_perm:[1,0,3,2] row_mask:0xf bank_mask:0xf
  v_add_f32_dpp v139, v139, v139 quad_perm:[1,0,3,2] row_mask:0xf bank_mask:0xf
  v_add_f32_dpp v140, v140, v140 quad_perm:[1,0,3,2] row_mask:0xf bank_mask:0xf
  v_add_f32_dpp v141, v141, v141 quad_perm:[1,0,3,2] row_mask:0xf bank_mask:0xf
  v_add_f32_dpp v142, v142, v142 quad_perm:[1,0,3,2] row_mask:0xf bank_mask:0xf
  v_add_f32_dpp v143, v143, v143 quad_perm:[1,0,3,2] row_mask:0xf bank_mask:0xf
  v_add_f32_dpp v136, v136, v136 quad_perm:[2,3,0,1] row_mask:0xf bank_mask:0xf
  v_add_f32_dpp v137, v137, v137 quad_perm:[2,3,0,1] row_mask:0xf bank_mask:0xf
  v_add_f32_dpp v138, v138, v138 quad_perm:[2,3,0,1] row_mask:0xf bank_mask:0xf
  v_add_f32_dpp v139, v139, v139 quad_perm:[2,3,0,1] row_mask:0xf bank_mask:0xf
  v_add_f32_dpp v140, v140, v140 quad_perm:[2,3,0,1] row_mask:0xf bank_mask:0xf
  v_add_f32_dpp v141, v141, v141 quad_perm:[2,3,0,1] row_mask:0xf bank_mask:0xf
  v_add_f32_dpp v142, v142, v142 quad_perm:[2,3,0,1] row_mask:0xf bank_mask:0xf
  v_add_f32_dpp v143, v143, v143 quad_perm:[2,3,0,1] row_mask:0xf bank_mask:0xf
  v_pk_fma_f32 v[72:73], v[210:211], v[136:137], v[72:73] op_sel_hi:[0,1,1] neg_lo:[1,0,0] neg_hi:[1,0,0]
  v_pk_fma_f32 v[74:75], v[210:211], v[138:139], v[74:75] op_sel_hi:[0,1,1] neg_lo:[1,0,0] neg_hi:[1,0,0]
  v_pk_mul_f32 v[72:73], v[210:211], v[72:73] op_sel:[1,0] op_sel_hi:[1,1]
  v_pk_mul_f32 v[74:75], v[210:211], v[74:75] op_sel:[1,0] op_sel_hi:[1,1]
  v_cvt_pk_bf16_f32 v72, v72, v73
  v_cvt_pk_bf16_f32 v73, v74, v75
  v_pk_max_i16 v216, v72, 0
  v_pk_max_i16 v217, v73, 0
  v_pk_fma_f32 v[76:77], v[210:211], v[140:141], v[76:77] op_sel_hi:[0,1,1] neg_lo:[1,0,0] neg_hi:[1,0,0]
  v_pk_fma_f32 v[78:79], v[210:211], v[142:143], v[78:79] op_sel_hi:[0,1,1] neg_lo:[1,0,0] neg_hi:[1,0,0]
  v_pk_mul_f32 v[76:77], v[210:211], v[76:77] op_sel:[1,0] op_sel_hi:[1,1]
  v_pk_mul_f32 v[78:79], v[210:211], v[78:79] op_sel:[1,0] op_sel_hi:[1,1]
  v_cvt_pk_bf16_f32 v76, v76, v77
  v_cvt_pk_bf16_f32 v77, v78, v79
  v_pk_max_i16 v218, v76, 0
  v_pk_max_i16 v219, v77, 0
  buffer_store_dwordx4 v[216:219], v5, s[36:39], s58 offen offset:2048
  v_pk_fma_f32 v[96:97], v[212:213], v[136:137], v[96:97] op_sel_hi:[0,1,1] neg_lo:[1,0,0] neg_hi:[1,0,0]
  v_pk_fma_f32 v[98:99], v[212:213], v[138:139], v[98:99] op_sel_hi:[0,1,1] neg_lo:[1,0,0] neg_hi:[1,0,0]
  v_pk_mul_f32 v[96:97], v[212:213], v[96:97] op_sel:[1,0] op_sel_hi:[1,1]
  v_pk_mul_f32 v[98:99], v[212:213], v[98:99] op_sel:[1,0] op_sel_hi:[1,1]
  v_cvt_pk_bf16_f32 v96, v96, v97
  v_cvt_pk_bf16_f32 v97, v98, v99
  v_pk_max_i16 v220, v96, 0
  v_pk_max_i16 v221, v97, 0
  v_pk_fma_f32 v[100:101], v[212:213], v[140:141], v[100:101] op_sel_hi:[0,1,1] neg_lo:[1,0,0] neg_hi:[1,0,0]
  v_pk_fma_f32 v[102:103], v[212:213], v[142:143], v[102:103] op_sel_hi:[0,1,1] neg_lo:[1,0,0] neg_hi:[1,0,0]
  v_pk_mul_f32 v[100:101], v[212:213], v[100:101] op_sel:[1,0] op_sel_hi:[1,1]
  v_pk_mul_f32 v[102:103], v[212:213], v[102:103] op_sel:[1,0] op_sel_hi:[1,1]
  v_cvt_pk_bf16_f32 v100, v100, v101
  v_cvt_pk_bf16_f32 v101, v102, v103
  v_pk_max_i16 v222, v100, 0
  v_pk_max_i16 v223, v101, 0
  buffer_store_dwordx4 v[220:223], v5, s[36:39], s59 offen offset:2048
L_C_CST:
  s_mul_i32 s54, s5, 2048
  s_add_u32 s54, s54, 9962496
  s_lshl_b32 s55, s6, 4
  s_add_u32 s54, s54, s55
  s_lshl_b32 s55, s4, 2
  s_add_u32 s54, s54, s55
  v_mov_b32 v6, 0
  s_waitcnt vmcnt(0)
  s_mov_b64 exec, 1
  buffer_store_dword v36, v6, s[36:39], s54 offen
  s_mov_b64 exec, -1
L_C_SKIPC:
  s_waitcnt vmcnt(0)
  v_mov_b32 v48, 0
  v_mov_b32 v49, 0
  v_mov_b32 v50, 0
  v_mov_b32 v51, 0
  v_mov_b32 v52, 0
  v_mov_b32 v53, 0
  v_mov_b32 v54, 0
  v_mov_b32 v55, 0
  v_mov_b32 v56, 0
  v_mov_b32 v57, 0
  v_mov_b32 v58, 0
  v_mov_b32 v59, 0
  v_mov_b32 v60, 0
  v_mov_b32 v61, 0
  v_mov_b32 v62, 0
  v_mov_b32 v63, 0
  s_barrier
  ds_read_b64_tr_b16 v[64:65], v40 offset:43008
  ds_read_b64_tr_b16 v[66:67], v40 offset:45056
  ds_read_b64_tr_b16 v[68:69], v42 offset:43008
  ds_read_b64_tr_b16 v[70:71], v42 offset:45056
  ds_read_b128 v[72:75], v39 offset:16384
  ds_read_b128 v[76:79], v39 offset:17408
  ds_read_b64_tr_b16 v[80:81], v40 offset:38912
  ds_read_b64_tr_b16 v[82:83], v40 offset:40960
  ds_read_b64_tr_b16 v[84:85], v42 offset:38912
  ds_read_b64_tr_b16 v[86:87], v42 offset:40960
  ds_read_b128 v[88:91], v39 offset:20480
  ds_read_b128 v[92:95], v39 offset:21504
  s_waitcnt lgkmcnt(0)
  v_mfma_f32_16x16x32_bf16 v[48:51], v[64:67], v[72:75], v[48:51]
  s_barrier
  v_mfma_f32_16x16x32_bf16 v[52:55], v[68:71], v[72:75], v[52:55]
  ds_read_b64_tr_b16 v[96:97], v40 offset:34816
  ds_read_b64_tr_b16 v[98:99], v40 offset:36864
  v_mfma_f32_16x16x32_bf16 v[56:59], v[64:67], v[76:79], v[56:59]
  ds_read_b64_tr_b16 v[100:101], v42 offset:34816
  ds_read_b64_tr_b16 v[102:103], v42 offset:36864
  v_mfma_f32_16x16x32_bf16 v[60:63], v[68:71], v[76:79], v[60:63]
  ds_read_b128 v[104:107], v39 offset:24576
  ds_read_b128 v[108:111], v39 offset:25600
  v_mfma_f32_16x16x32_bf16 v[48:51], v[80:83], v[88:91], v[48:51]
  ds_read_b64_tr_b16 v[112:113], v40 offset:30720
  ds_read_b64_tr_b16 v[114:115], v40 offset:32768
  v_mfma_f32_16x16x32_bf16 v[52:55], v[84:87], v[88:91], v[52:55]
  ds_read_b64_tr_b16 v[116:117], v42 offset:30720
  ds_read_b64_tr_b16 v[118:119], v42 offset:32768
  v_mfma_f32_16x16x32_bf16 v[56:59], v[80:83], v[92:95], v[56:59]
  ds_read_b128 v[120:123], v39 offset:28672
  ds_read_b128 v[124:127], v39 offset:29696
  v_mfma_f32_16x16x32_bf16 v[60:63], v[84:87], v[92:95], v[60:63]
  s_waitcnt lgkmcnt(0)
  v_mfma_f32_16x16x32_bf16 v[48:51], v[96:99], v[104:107], v[48:51]
  s_barrier
  v_mfma_f32_16x16x32_bf16 v[52:55], v[100:103], v[104:107], v[52:55]
  ds_read_b64_tr_b16 v[64:65], v40 offset:2048
  ds_read_b64_tr_b16 v[66:67], v40 offset:4096
  v_mfma_f32_16x16x32_bf16 v[56:59], v[96:99], v[108:111], v[56:59]
  ds_read_b64_tr_b16 v[68:69], v42 offset:2048
  ds_read_b64_tr_b16 v[70:71], v42 offset:4096
  v_mfma_f32_16x16x32_bf16 v[60:63], v[100:103], v[108:111], v[60:63]
  ds_read_b128 v[72:75], v39 offset:32768
  ds_read_b128 v[76:79], v39 offset:33792
  v_mfma_f32_16x16x32_bf16 v[48:51], v[112:115], v[120:123], v[48:51]
  ds_read_b64_tr_b16 v[80:81], v37 offset:63488
  ds_read_b64_tr_b16 v[82:83], v40 offset:0
  v_mfma_f32_16x16x32_bf16 v[52:55], v[116:119], v[120:123], v[52:55]
  ds_read_b64_tr_b16 v[84:85], v38 offset:63488
  ds_read_b64_tr_b16 v[86:87], v42 offset:0
  v_mfma_f32_16x16x32_bf16 v[56:59], v[112:115], v[124:127], v[56:59]
  ds_read_b128 v[88:91], v39 offset:40960
  ds_read_b128 v[92:95], v39 offset:41984
  v_mfma_f32_16x16x32_bf16 v[60:63], v[116:119], v[124:127], v[60:63]
  s_waitcnt lgkmcnt(0)
  v_mfma_f32_16x16x32_bf16 v[48:51], v[64:67], v[72:75], v[48:51]
  ds_read_b64_tr_b16 v[96:97], v37 offset:59392
  ds_read_b64_tr_b16 v[98:99], v37 offset:61440
  v_mfma_f32_16x16x32_bf16 v[52:55], v[68:71], v[72:75], v[52:55]
  ds_read_b64_tr_b16 v[100:101], v38 offset:59392
  ds_read_b64_tr_b16 v[102:103], v38 offset:61440
  v_mfma_f32_16x16x32_bf16 v[56:59], v[64:67], v[76:79], v[56:59]
  ds_read_b128 v[104:107], v39 offset:45056
  ds_read_b128 v[108:111], v39 offset:46080
  v_mfma_f32_16x16x32_bf16 v[60:63], v[68:71], v[76:79], v[60:63]
  ds_read_b64_tr_b16 v[112:113], v37 offset:12288
  ds_read_b64_tr_b16 v[114:115], v37 offset:14336
  v_mfma_f32_16x16x32_bf16 v[48:51], v[80:83], v[88:91], v[48:51]
  ds_read_b64_tr_b16 v[116:117], v38 offset:12288
  ds_read_b64_tr_b16 v[118:119], v38 offset:14336
  v_mfma_f32_16x16x32_bf16 v[52:55], v[84:87], v[88:91], v[52:55]
  ds_read_b128 v[120:123], v39 offset:49152
  ds_read_b128 v[124:127], v39 offset:50176
  v_mfma_f32_16x16x32_bf16 v[56:59], v[80:83], v[92:95], v[56:59]
  v_mfma_f32_16x16x32_bf16 v[60:63], v[84:87], v[92:95], v[60:63]
  s_waitcnt lgkmcnt(0)
  v_mfma_f32_16x16x32_bf16 v[48:51], v[96:99], v[104:107], v[48:51]
  s_barrier
  v_mfma_f32_16x16x32_bf16 v[52:55], v[100:103], v[104:107], v[52:55]
  ds_read_b64_tr_b16 v[64:65], v37 offset:8192
  ds_read_b64_tr_b16 v[66:67], v37 offset:10240
  v_mfma_f32_16x16x32_bf16 v[56:59], v[96:99], v[108:111], v[56:59]
  ds_read_b64_tr_b16 v[68:69], v38 offset:8192
  ds_read_b64_tr_b16 v[70:71], v38 offset:10240
  v_mfma_f32_16x16x32_bf16 v[60:63], v[100:103], v[108:111], v[60:63]
  ds_read_b128 v[72:75], v39 offset:53248
  ds_read_b128 v[76:79], v39 offset:54272
  v_mfma_f32_16x16x32_bf16 v[48:51], v[112:115], v[120:123], v[48:51]
  ds_read_b64_tr_b16 v[80:81], v37 offset:4096
  ds_read_b64_tr_b16 v[82:83], v37 offset:6144
  v_mfma_f32_16x16x32_bf16 v[52:55], v[116:119], v[120:123], v[52:55]
  ds_read_b64_tr_b16 v[84:85], v38 offset:4096
  ds_read_b64_tr_b16 v[86:87], v38 offset:6144
  v_mfma_f32_16x16x32_bf16 v[56:59], v[112:115], v[124:127], v[56:59]
  ds_read_b128 v[88:91], v45 offset:18432
  ds_read_b128 v[92:95], v45 offset:19456
  v_mfma_f32_16x16x32_bf16 v[60:63], v[116:119], v[124:127], v[60:63]
  s_waitcnt lgkmcnt(0)
  v_mfma_f32_16x16x32_bf16 v[48:51], v[64:67], v[72:75], v[48:51]
  ds_read_b64_tr_b16 v[96:97], v37 offset:0
  ds_read_b64_tr_b16 v[98:99], v37 offset:2048
  v_mfma_f32_16x16x32_bf16 v[52:55], v[68:71], v[72:75], v[52:55]
  ds_read_b64_tr_b16 v[100:101], v38 offset:0
  ds_read_b64_tr_b16 v[102:103], v38 offset:2048
  v_mfma_f32_16x16x32_bf16 v[56:59], v[64:67], v[76:79], v[56:59]
  ds_read_b128 v[104:107], v45 offset:22528
  ds_read_b128 v[108:111], v45 offset:23552
  v_mfma_f32_16x16x32_bf16 v[60:63], v[68:71], v[76:79], v[60:63]
  ds_read_b64_tr_b16 v[112:113], v41 offset:14336
  ds_read_b64_tr_b16 v[114:115], v41 offset:16384
  v_mfma_f32_16x16x32_bf16 v[48:51], v[80:83], v[88:91], v[48:51]
  ds_read_b64_tr_b16 v[116:117], v43 offset:14336
  ds_read_b64_tr_b16 v[118:119], v43 offset:16384
  v_mfma_f32_16x16x32_bf16 v[52:55], v[84:87], v[88:91], v[52:55]
  ds_read_b128 v[120:123], v45 offset:26624
  ds_read_b128 v[124:127], v45 offset:27648
  v_mfma_f32_16x16x32_bf16 v[56:59], v[80:83], v[92:95], v[56:59]
  v_mfma_f32_16x16x32_bf16 v[60:63], v[84:87], v[92:95], v[60:63]
  s_waitcnt lgkmcnt(0)
  v_mfma_f32_16x16x32_bf16 v[48:51], v[96:99], v[104:107], v[48:51]
  s_barrier
  v_mfma_f32_16x16x32_bf16 v[52:55], v[100:103], v[104:107], v[52:55]
  ds_read_b64_tr_b16 v[64:65], v41 offset:10240
  ds_read_b64_tr_b16 v[66:67], v41 offset:12288
  v_mfma_f32_16x16x32_bf16 v[56:59], v[96:99], v[108:111], v[56:59]
  ds_read_b64_tr_b16 v[68:69], v43 offset:10240
  ds_read_b64_tr_b16 v[70:71], v43 offset:12288
  v_mfma_f32_16x16x32_bf16 v[60:63], v[100:103], v[108:111], v[60:63]
  ds_read_b128 v[72:75], v39 offset:16384
  ds_read_b128 v[76:79], v39 offset:17408
  v_mfma_f32_16x16x32_bf16 v[48:51], v[112:115], v[120:123], v[48:51]
  ds_read_b64_tr_b16 v[80:81], v41 offset:6144
  ds_read_b64_tr_b16 v[82:83], v41 offset:8192
  v_mfma_f32_16x16x32_bf16 v[52:55], v[116:119], v[120:123], v[52:55]
  ds_read_b64_tr_b16 v[84:85], v43 offset:6144
  ds_read_b64_tr_b16 v[86:87], v43 offset:8192
  v_mfma_f32_16x16x32_bf16 v[56:59], v[112:115], v[124:127], v[56:59]
  ds_read_b128 v[88:91], v39 offset:20480
  ds_read_b128 v[92:95], v39 offset:21504
  v_mfma_f32_16x16x32_bf16 v[60:63], v[116:119], v[124:127], v[60:63]
  s_waitcnt lgkmcnt(0)
  v_mfma_f32_16x16x32_bf16 v[48:51], v[64:67], v[72:75], v[48:51]
  ds_read_b64_tr_b16 v[96:97], v40 offset:59392
  ds_read_b64_tr_b16 v[98:99], v40 offset:61440
  v_mfma_f32_16x16x32_bf16 v[52:55], v[68:71], v[72:75], v[52:55]
  ds_read_b64_tr_b16 v[100:101], v42 offset:59392
  ds_read_b64_tr_b16 v[102:103], v42 offset:61440
  v_mfma_f32_16x16x32_bf16 v[56:59], v[64:67], v[76:79], v[56:59]
  ds_read_b128 v[104:107], v44 offset:38912
  ds_read_b128 v[108:111], v44 offset:39936
  v_mfma_f32_16x16x32_bf16 v[60:63], v[68:71], v[76:79], v[60:63]
  ds_read_b64_tr_b16 v[112:113], v40 offset:55296
  ds_read_b64_tr_b16 v[114:115], v40 offset:57344
  v_mfma_f32_16x16x32_bf16 v[48:51], v[80:83], v[88:91], v[48:51]
  ds_read_b64_tr_b16 v[116:117], v42 offset:55296
  ds_read_b64_tr_b16 v[118:119], v42 offset:57344
  v_mfma_f32_16x16x32_bf16 v[52:55], v[84:87], v[88:91], v[52:55]
  ds_read_b128 v[120:123], v44 offset:43008
  ds_read_b128 v[124:127], v44 offset:44032
  v_mfma_f32_16x16x32_bf16 v[56:59], v[80:83], v[92:95], v[56:59]
  v_mfma_f32_16x16x32_bf16 v[60:63], v[84:87], v[92:95], v[60:63]
  s_waitcnt lgkmcnt(0)
  v_mfma_f32_16x16x32_bf16 v[48:51], v[96:99], v[104:107], v[48:51]
  ds_read_b64_tr_b16 v[64:65], v41 offset:2048
  ds_read_b64_tr_b16 v[66:67], v41 offset:4096
  v_mfma_f32_16x16x32_bf16 v[52:55], v[100:103], v[104:107], v[52:55]
  ds_read_b64_tr_b16 v[68:69], v43 offset:2048
  ds_read_b64_tr_b16 v[70:71], v43 offset:4096
  v_mfma_f32_16x16x32_bf16 v[56:59], v[96:99], v[108:111], v[56:59]
  ds_read_b128 v[72:75], v39 offset:24576
  ds_read_b128 v[76:79], v39 offset:25600
  v_mfma_f32_16x16x32_bf16 v[60:63], v[100:103], v[108:111], v[60:63]
  ds_read_b64_tr_b16 v[80:81], v40 offset:63488
  ds_read_b64_tr_b16 v[82:83], v41 offset:0
  v_mfma_f32_16x16x32_bf16 v[48:51], v[112:115], v[120:123], v[48:51]
  ds_read_b64_tr_b16 v[84:85], v42 offset:63488
  ds_read_b64_tr_b16 v[86:87], v43 offset:0
  v_mfma_f32_16x16x32_bf16 v[52:55], v[116:119], v[120:123], v[52:55]
  ds_read_b128 v[88:91], v39 offset:28672
  ds_read_b128 v[92:95], v39 offset:29696
  v_mfma_f32_16x16x32_bf16 v[56:59], v[112:115], v[124:127], v[56:59]
  v_mfma_f32_16x16x32_bf16 v[60:63], v[116:119], v[124:127], v[60:63]
  s_waitcnt lgkmcnt(0)
  v_mfma_f32_16x16x32_bf16 v[48:51], v[64:67], v[72:75], v[48:51]
  s_barrier
  v_mfma_f32_16x16x32_bf16 v[52:55], v[68:71], v[72:75], v[52:55]
  ds_read_b64_tr_b16 v[96:97], v40 offset:51200
  ds_read_b64_tr_b16 v[98:99], v40 offset:53248
  v_mfma_f32_16x16x32_bf16 v[56:59], v[64:67], v[76:79], v[56:59]
  ds_read_b64_tr_b16 v[100:101], v42 offset:51200
  ds_read_b64_tr_b16 v[102:103], v42 offset:53248
  v_mfma_f32_16x16x32_bf16 v[60:63], v[68:71], v[76:79], v[60:63]
  ds_read_b128 v[104:107], v44 offset:30720
  ds_read_b128 v[108:111], v44 offset:31744
  v_mfma_f32_16x16x32_bf16 v[48:51], v[80:83], v[88:91], v[48:51]
  ds_read_b64_tr_b16 v[112:113], v40 offset:47104
  ds_read_b64_tr_b16 v[114:115], v40 offset:49152
  v_mfma_f32_16x16x32_bf16 v[52:55], v[84:87], v[88:91], v[52:55]
  ds_read_b64_tr_b16 v[116:117], v42 offset:47104
  ds_read_b64_tr_b16 v[118:119], v42 offset:49152
  v_mfma_f32_16x16x32_bf16 v[56:59], v[80:83], v[92:95], v[56:59]
  ds_read_b128 v[120:123], v44 offset:34816
  ds_read_b128 v[124:127], v44 offset:35840
  v_mfma_f32_16x16x32_bf16 v[60:63], v[84:87], v[92:95], v[60:63]
  s_waitcnt lgkmcnt(0)
  v_mfma_f32_16x16x32_bf16 v[48:51], v[96:99], v[104:107], v[48:51]
  ds_read_b64_tr_b16 v[64:65], v40 offset:26624
  ds_read_b64_tr_b16 v[66:67], v40 offset:28672
  v_mfma_f32_16x16x32_bf16 v[52:55], v[100:103], v[104:107], v[52:55]
  ds_read_b64_tr_b16 v[68:69], v42 offset:26624
  ds_read_b64_tr_b16 v[70:71], v42 offset:28672
  v_mfma_f32_16x16x32_bf16 v[56:59], v[96:99], v[108:111], v[56:59]
  ds_read_b128 v[72:75], v39 offset:12288
  ds_read_b128 v[76:79], v39 offset:13312
  v_mfma_f32_16x16x32_bf16 v[60:63], v[100:103], v[108:111], v[60:63]
  ds_read_b64_tr_b16 v[80:81], v40 offset:22528
  ds_read_b64_tr_b16 v[82:83], v40 offset:24576
  v_mfma_f32_16x16x32_bf16 v[48:51], v[112:115], v[120:123], v[48:51]
  ds_read_b64_tr_b16 v[84:85], v42 offset:22528
  ds_read_b64_tr_b16 v[86:87], v42 offset:24576
  v_mfma_f32_16x16x32_bf16 v[52:55], v[116:119], v[120:123], v[52:55]
  ds_read_b128 v[88:91], v39 offset:32768
  ds_read_b128 v[92:95], v39 offset:33792
  v_mfma_f32_16x16x32_bf16 v[56:59], v[112:115], v[124:127], v[56:59]
  v_mfma_f32_16x16x32_bf16 v[60:63], v[116:119], v[124:127], v[60:63]
  s_waitcnt lgkmcnt(0)
  v_mfma_f32_16x16x32_bf16 v[48:51], v[64:67], v[72:75], v[48:51]
  ds_read_b64_tr_b16 v[96:97], v40 offset:18432
  ds_read_b64_tr_b16 v[98:99], v40 offset:20480
  v_mfma_f32_16x16x32_bf16 v[52:55], v[68:71], v[72:75], v[52:55]
  ds_read_b64_tr_b16 v[100:101], v42 offset:18432
  ds_read_b64_tr_b16 v[102:103], v42 offset:20480
  v_mfma_f32_16x16x32_bf16 v[56:59], v[64:67], v[76:79], v[56:59]
  ds_read_b128 v[104:107], v39 offset:40960
  ds_read_b128 v[108:111], v39 offset:41984
  v_mfma_f32_16x16x32_bf16 v[60:63], v[68:71], v[76:79], v[60:63]
  ds_read_b64_tr_b16 v[112:113], v40 offset:14336
  ds_read_b64_tr_b16 v[114:115], v40 offset:16384
  v_mfma_f32_16x16x32_bf16 v[48:51], v[80:83], v[88:91], v[48:51]
  ds_read_b64_tr_b16 v[116:117], v42 offset:14336
  ds_read_b64_tr_b16 v[118:119], v42 offset:16384
  v_mfma_f32_16x16x32_bf16 v[52:55], v[84:87], v[88:91], v[52:55]
  ds_read_b128 v[120:123], v39 offset:45056
  ds_read_b128 v[124:127], v39 offset:46080
  v_mfma_f32_16x16x32_bf16 v[56:59], v[80:83], v[92:95], v[56:59]
  v_mfma_f32_16x16x32_bf16 v[60:63], v[84:87], v[92:95], v[60:63]
  s_waitcnt lgkmcnt(0)
  v_mfma_f32_16x16x32_bf16 v[48:51], v[96:99], v[104:107], v[48:51]
  s_barrier
  v_mfma_f32_16x16x32_bf16 v[52:55], v[100:103], v[104:107], v[52:55]
  ds_read_b64_tr_b16 v[64:65], v40 offset:10240
  ds_read_b64_tr_b16 v[66:67], v40 offset:12288
  v_mfma_f32_16x16x32_bf16 v[56:59], v[96:99], v[108:111], v[56:59]
  ds_read_b64_tr_b16 v[68:69], v42 offset:10240
  ds_read_b64_tr_b16 v[70:71], v42 offset:12288
  v_mfma_f32_16x16x32_bf16 v[60:63], v[100:103], v[108:111], v[60:63]
  ds_read_b128 v[72:75], v39 offset:49152
  ds_read_b128 v[76:79], v39 offset:50176
  v_mfma_f32_16x16x32_bf16 v[48:51], v[112:115], v[120:123], v[48:51]
  ds_read_b64_tr_b16 v[80:81], v40 offset:6144
  ds_read_b64_tr_b16 v[82:83], v40 offset:8192
  v_mfma_f32_16x16x32_bf16 v[52:55], v[116:119], v[120:123], v[52:55]
  ds_read_b64_tr_b16 v[84:85], v42 offset:6144
  ds_read_b64_tr_b16 v[86:87], v42 offset:8192
  v_mfma_f32_16x16x32_bf16 v[56:59], v[112:115], v[124:127], v[56:59]
  ds_read_b128 v[88:91], v39 offset:57344
  ds_read_b128 v[92:95], v39 offset:58368
  v_mfma_f32_16x16x32_bf16 v[60:63], v[116:119], v[124:127], v[60:63]
  s_waitcnt lgkmcnt(0)
  v_mfma_f32_16x16x32_bf16 v[48:51], v[64:67], v[72:75], v[48:51]
  ds_read_b64_tr_b16 v[96:97], v37 offset:36864
  ds_read_b64_tr_b16 v[98:99], v37 offset:38912
  v_mfma_f32_16x16x32_bf16 v[52:55], v[68:71], v[72:75], v[52:55]
  ds_read_b64_tr_b16 v[100:101], v38 offset:36864
  ds_read_b64_tr_b16 v[102:103], v38 offset:38912
  v_mfma_f32_16x16x32_bf16 v[56:59], v[64:67], v[76:79], v[56:59]
  ds_read_b128 v[104:107], v39 offset:61440
  ds_read_b128 v[108:111], v39 offset:62464
  v_mfma_f32_16x16x32_bf16 v[60:63], v[68:71], v[76:79], v[60:63]
  ds_read_b64_tr_b16 v[112:113], v41 offset:26624
  ds_read_b64_tr_b16 v[114:115], v41 offset:28672
  v_mfma_f32_16x16x32_bf16 v[48:51], v[80:83], v[88:91], v[48:51]
  ds_read_b64_tr_b16 v[116:117], v43 offset:26624
  ds_read_b64_tr_b16 v[118:119], v43 offset:28672
  v_mfma_f32_16x16x32_bf16 v[52:55], v[84:87], v[88:91], v[52:55]
  ds_read_b128 v[120:123], v44 offset:0
  ds_read_b128 v[124:127], v44 offset:1024
  v_mfma_f32_16x16x32_bf16 v[56:59], v[80:83], v[92:95], v[56:59]
  v_mfma_f32_16x16x32_bf16 v[60:63], v[84:87], v[92:95], v[60:63]
  s_waitcnt lgkmcnt(0)
  v_mfma_f32_16x16x32_bf16 v[48:51], v[96:99], v[104:107], v[48:51]
  ds_read_b64_tr_b16 v[64:65], v41 offset:22528
  ds_read_b64_tr_b16 v[66:67], v41 offset:24576
  v_mfma_f32_16x16x32_bf16 v[52:55], v[100:103], v[104:107], v[52:55]
  ds_read_b64_tr_b16 v[68:69], v43 offset:22528
  ds_read_b64_tr_b16 v[70:71], v43 offset:24576
  v_mfma_f32_16x16x32_bf16 v[56:59], v[96:99], v[108:111], v[56:59]
  ds_read_b128 v[72:75], v39 offset:0
  ds_read_b128 v[76:79], v39 offset:1024
  v_mfma_f32_16x16x32_bf16 v[60:63], v[100:103], v[108:111], v[60:63]
  ds_read_b64_tr_b16 v[80:81], v41 offset:18432
  ds_read_b64_tr_b16 v[82:83], v41 offset:20480
  v_mfma_f32_16x16x32_bf16 v[48:51], v[112:115], v[120:123], v[48:51]
  ds_read_b64_tr_b16 v[84:85], v43 offset:18432
  ds_read_b64_tr_b16 v[86:87], v43 offset:20480
  v_mfma_f32_16x16x32_bf16 v[52:55], v[116:119], v[120:123], v[52:55]
  ds_read_b128 v[88:91], v39 offset:4096
  ds_read_b128 v[92:95], v39 offset:5120
  v_mfma_f32_16x16x32_bf16 v[56:59], v[112:115], v[124:127], v[56:59]
  v_mfma_f32_16x16x32_bf16 v[60:63], v[116:119], v[124:127], v[60:63]
  s_waitcnt lgkmcnt(0)
  v_mfma_f32_16x16x32_bf16 v[48:51], v[64:67], v[72:75], v[48:51]
  s_barrier
  v_mfma_f32_16x16x32_bf16 v[52:55], v[68:71], v[72:75], v[52:55]
  ds_read_b64_tr_b16 v[96:97], v41 offset:10240
  ds_read_b64_tr_b16 v[98:99], v41 offset:12288
  v_mfma_f32_16x16x32_bf16 v[56:59], v[64:67], v[76:79], v[56:59]
  ds_read_b64_tr_b16 v[100:101], v43 offset:10240
  ds_read_b64_tr_b16 v[102:103], v43 offset:12288
  v_mfma_f32_16x16x32_bf16 v[60:63], v[68:71], v[76:79], v[60:63]
  ds_read_b128 v[104:107], v39 offset:8192
  ds_read_b128 v[108:111], v39 offset:9216
  v_mfma_f32_16x16x32_bf16 v[48:51], v[80:83], v[88:91], v[48:51]
  ds_read_b64_tr_b16 v[112:113], v41 offset:6144
  ds_read_b64_tr_b16 v[114:115], v41 offset:8192
  v_mfma_f32_16x16x32_bf16 v[52:55], v[84:87], v[88:91], v[52:55]
  ds_read_b64_tr_b16 v[116:117], v43 offset:6144
  ds_read_b64_tr_b16 v[118:119], v43 offset:8192
  v_mfma_f32_16x16x32_bf16 v[56:59], v[80:83], v[92:95], v[56:59]
  ds_read_b128 v[120:123], v39 offset:53248
  ds_read_b128 v[124:127], v39 offset:54272
  v_mfma_f32_16x16x32_bf16 v[60:63], v[84:87], v[92:95], v[60:63]
  s_waitcnt lgkmcnt(0)
  v_mfma_f32_16x16x32_bf16 v[48:51], v[96:99], v[104:107], v[48:51]
  ds_read_b64_tr_b16 v[64:65], v41 offset:2048
  ds_read_b64_tr_b16 v[66:67], v41 offset:4096
  v_mfma_f32_16x16x32_bf16 v[52:55], v[100:103], v[104:107], v[52:55]
  ds_read_b64_tr_b16 v[68:69], v43 offset:2048
  ds_read_b64_tr_b16 v[70:71], v43 offset:4096
  v_mfma_f32_16x16x32_bf16 v[56:59], v[96:99], v[108:111], v[56:59]
  ds_read_b128 v[72:75], v45 offset:14336
  ds_read_b128 v[76:79], v45 offset:15360
  v_mfma_f32_16x16x32_bf16 v[60:63], v[100:103], v[108:111], v[60:63]
  ds_read_b64_tr_b16 v[80:81], v40 offset:63488
  ds_read_b64_tr_b16 v[82:83], v41 offset:0
  v_mfma_f32_16x16x32_bf16 v[48:51], v[112:115], v[120:123], v[48:51]
  ds_read_b64_tr_b16 v[84:85], v42 offset:63488
  ds_read_b64_tr_b16 v[86:87], v43 offset:0
  v_mfma_f32_16x16x32_bf16 v[52:55], v[116:119], v[120:123], v[52:55]
  ds_read_b128 v[88:91], v39 offset:16384
  ds_read_b128 v[92:95], v39 offset:17408
  v_mfma_f32_16x16x32_bf16 v[56:59], v[112:115], v[124:127], v[56:59]
  v_mfma_f32_16x16x32_bf16 v[60:63], v[116:119], v[124:127], v[60:63]
  s_waitcnt lgkmcnt(0)
  v_mfma_f32_16x16x32_bf16 v[48:51], v[64:67], v[72:75], v[48:51]
  ds_read_b64_tr_b16 v[96:97], v40 offset:59392
  ds_read_b64_tr_b16 v[98:99], v40 offset:61440
  v_mfma_f32_16x16x32_bf16 v[52:55], v[68:71], v[72:75], v[52:55]
  ds_read_b64_tr_b16 v[100:101], v42 offset:59392
  ds_read_b64_tr_b16 v[102:103], v42 offset:61440
  v_mfma_f32_16x16x32_bf16 v[56:59], v[64:67], v[76:79], v[56:59]
  ds_read_b128 v[104:107], v39 offset:20480
  ds_read_b128 v[108:111], v39 offset:21504
  v_mfma_f32_16x16x32_bf16 v[60:63], v[68:71], v[76:79], v[60:63]
  ds_read_b64_tr_b16 v[112:113], v40 offset:55296
  ds_read_b64_tr_b16 v[114:115], v40 offset:57344
  v_mfma_f32_16x16x32_bf16 v[48:51], v[80:83], v[88:91], v[48:51]
  ds_read_b64_tr_b16 v[116:117], v42 offset:55296
  ds_read_b64_tr_b16 v[118:119], v42 offset:57344
  v_mfma_f32_16x16x32_bf16 v[52:55], v[84:87], v[88:91], v[52:55]
  ds_read_b128 v[120:123], v39 offset:24576
  ds_read_b128 v[124:127], v39 offset:25600
  v_mfma_f32_16x16x32_bf16 v[56:59], v[80:83], v[92:95], v[56:59]
  v_mfma_f32_16x16x32_bf16 v[60:63], v[84:87], v[92:95], v[60:63]
  s_waitcnt lgkmcnt(0)
  v_mfma_f32_16x16x32_bf16 v[48:51], v[96:99], v[104:107], v[48:51]
  s_barrier
  v_mfma_f32_16x16x32_bf16 v[52:55], v[100:103], v[104:107], v[52:55]
  ds_read_b64_tr_b16 v[64:65], v40 offset:51200
  ds_read_b64_tr_b16 v[66:67], v40 offset:53248
  v_mfma_f32_16x16x32_bf16 v[56:59], v[96:99], v[108:111], v[56:59]
  ds_read_b64_tr_b16 v[68:69], v42 offset:51200
  ds_read_b64_tr_b16 v[70:71], v42 offset:53248
  v_mfma_f32_16x16x32_bf16 v[60:63], v[100:103], v[108:111], v[60:63]
  ds_read_b128 v[72:75], v39 offset:28672
  ds_read_b128 v[76:79], v39 offset:29696
  v_mfma_f32_16x16x32_bf16 v[48:51], v[112:115], v[120:123], v[48:51]
  ds_read_b64_tr_b16 v[80:81], v40 offset:47104
  ds_read_b64_tr_b16 v[82:83], v40 offset:49152
  v_mfma_f32_16x16x32_bf16 v[52:55], v[116:119], v[120:123], v[52:55]
  ds_read_b64_tr_b16 v[84:85], v42 offset:47104
  ds_read_b64_tr_b16 v[86:87], v42 offset:49152
  v_mfma_f32_16x16x32_bf16 v[56:59], v[112:115], v[124:127], v[56:59]
  ds_read_b128 v[88:91], v44 offset:38912
  ds_read_b128 v[92:95], v44 offset:39936
  v_mfma_f32_16x16x32_bf16 v[60:63], v[116:119], v[124:127], v[60:63]
  s_waitcnt lgkmcnt(0)
  v_mfma_f32_16x16x32_bf16 v[48:51], v[64:67], v[72:75], v[48:51]
  ds_read_b64_tr_b16 v[96:97], v40 offset:34816
  ds_read_b64_tr_b16 v[98:99], v40 offset:36864
  v_mfma_f32_16x16x32_bf16 v[52:55], v[68:71], v[72:75], v[52:55]
  ds_read_b64_tr_b16 v[100:101], v42 offset:34816
  ds_read_b64_tr_b16 v[102:103], v42 offset:36864
  v_mfma_f32_16x16x32_bf16 v[56:59], v[64:67], v[76:79], v[56:59]
  ds_read_b128 v[104:107], v44 offset:43008
  ds_read_b128 v[108:111], v44 offset:44032
  v_mfma_f32_16x16x32_bf16 v[60:63], v[68:71], v[76:79], v[60:63]
  ds_read_b64_tr_b16 v[112:113], v40 offset:30720
  ds_read_b64_tr_b16 v[114:115], v40 offset:32768
  v_mfma_f32_16x16x32_bf16 v[48:51], v[80:83], v[88:91], v[48:51]
  ds_read_b64_tr_b16 v[116:117], v42 offset:30720
  ds_read_b64_tr_b16 v[118:119], v42 offset:32768
  v_mfma_f32_16x16x32_bf16 v[52:55], v[84:87], v[88:91], v[52:55]
  ds_read_b128 v[120:123], v39 offset:12288
  ds_read_b128 v[124:127], v39 offset:13312
  v_mfma_f32_16x16x32_bf16 v[56:59], v[80:83], v[92:95], v[56:59]
  v_mfma_f32_16x16x32_bf16 v[60:63], v[84:87], v[92:95], v[60:63]
  s_waitcnt lgkmcnt(0)
  v_mfma_f32_16x16x32_bf16 v[48:51], v[96:99], v[104:107], v[48:51]
  ds_read_b64_tr_b16 v[64:65], v40 offset:26624
  ds_read_b64_tr_b16 v[66:67], v40 offset:28672
  v_mfma_f32_16x16x32_bf16 v[52:55], v[100:103], v[104:107], v[52:55]
  ds_read_b64_tr_b16 v[68:69], v42 offset:26624
  ds_read_b64_tr_b16 v[70:71], v42 offset:28672
  v_mfma_f32_16x16x32_bf16 v[56:59], v[96:99], v[108:111], v[56:59]
  ds_read_b128 v[72:75], v39 offset:32768
  ds_read_b128 v[76:79], v39 offset:33792
  v_mfma_f32_16x16x32_bf16 v[60:63], v[100:103], v[108:111], v[60:63]
  ds_read_b64_tr_b16 v[80:81], v40 offset:22528
  ds_read_b64_tr_b16 v[82:83], v40 offset:24576
  v_mfma_f32_16x16x32_bf16 v[48:51], v[112:115], v[120:123], v[48:51]
  ds_read_b64_tr_b16 v[84:85], v42 offset:22528
  ds_read_b64_tr_b16 v[86:87], v42 offset:24576
  v_mfma_f32_16x16x32_bf16 v[52:55], v[116:119], v[120:123], v[52:55]
  ds_read_b128 v[88:91], v39 offset:40960
  ds_read_b128 v[92:95], v39 offset:41984
  v_mfma_f32_16x16x32_bf16 v[56:59], v[112:115], v[124:127], v[56:59]
  v_mfma_f32_16x16x32_bf16 v[60:63], v[116:119], v[124:127], v[60:63]
  s_waitcnt lgkmcnt(0)
  v_mfma_f32_16x16x32_bf16 v[48:51], v[64:67], v[72:75], v[48:51]
  ds_read_b64_tr_b16 v[96:97], v40 offset:18432
  v_mfma_f32_16x16x32_bf16 v[52:55], v[68:71], v[72:75], v[52:55]
  ds_read_b64_tr_b16 v[98:99], v40 offset:20480
  v_mfma_f32_16x16x32_bf16 v[56:59], v[64:67], v[76:79], v[56:59]
  ds_read_b64_tr_b16 v[100:101], v42 offset:18432
  v_mfma_f32_16x16x32_bf16 v[60:63], v[68:71], v[76:79], v[60:63]
  ds_read_b64_tr_b16 v[102:103], v42 offset:20480
  v_mfma_f32_16x16x32_bf16 v[48:51], v[80:83], v[88:91], v[48:51]
  ds_read_b128 v[104:107], v39 offset:45056
  v_mfma_f32_16x16x32_bf16 v[52:55], v[84:87], v[88:91], v[52:55]
  ds_read_b128 v[108:111], v39 offset:46080
  v_mfma_f32_16x16x32_bf16 v[56:59], v[80:83], v[92:95], v[56:59]
  v_mfma_f32_16x16x32_bf16 v[60:63], v[84:87], v[92:95], v[60:63]
  s_waitcnt lgkmcnt(0)
  v_mfma_f32_16x16x32_bf16 v[48:51], v[96:99], v[104:107], v[48:51]
  v_mfma_f32_16x16x32_bf16 v[52:55], v[100:103], v[104:107], v[52:55]
  v_mfma_f32_16x16x32_bf16 v[56:59], v[96:99], v[108:111], v[56:59]
  v_mfma_f32_16x16x32_bf16 v[60:63], v[100:103], v[108:111], v[60:63]
  v_and_b32 v6, 1, v4
  v_lshlrev_b32 v6, 5, v6
  v_lshrrev_b32 v7, 1, v4
  v_lshl_add_u32 v6, v7, 4, v6
  v_lshl_add_u32 v128, v3, 11, v6
  v_cvt_pk_bf16_f32 v6, v48, v49
  v_cvt_pk_bf16_f32 v7, v50, v51
  v_lshlrev_b32 v48, 16, v6
  v_and_b32 v49, 0xffff0000, v6
  v_lshlrev_b32 v50, 16, v7
  v_and_b32 v51, 0xffff0000, v7
  v_lshlrev_b32 v6, 16, v16
  v_and_b32 v7, 0xffff0000, v16
  v_lshlrev_b32 v8, 16, v17
  v_and_b32 v9, 0xffff0000, v17
  v_add_f32 v48, v48, v6
  v_add_f32 v49, v49, v7
  v_add_f32 v50, v50, v8
  v_add_f32 v51, v51, v9
  v_cvt_pk_bf16_f32 v132, v48, v49
  v_cvt_pk_bf16_f32 v133, v50, v51
  v_cvt_pk_bf16_f32 v6, v52, v53
  v_cvt_pk_bf16_f32 v7, v54, v55
  v_lshlrev_b32 v52, 16, v6
  v_and_b32 v53, 0xffff0000, v6
  v_lshlrev_b32 v54, 16, v7
  v_and_b32 v55, 0xffff0000, v7
  v_lshlrev_b32 v6, 16, v18
  v_and_b32 v7, 0xffff0000, v18
  v_lshlrev_b32 v8, 16, v19
  v_and_b32 v9, 0xffff0000, v19
  v_add_f32 v52, v52, v6
  v_add_f32 v53, v53, v7
  v_add_f32 v54, v54, v8
  v_add_f32 v55, v55, v9
  v_cvt_pk_bf16_f32 v134, v52, v53
  v_cvt_pk_bf16_f32 v135, v54, v55
  s_nop 0
  v_permlane16_swap_b32 v132, v134
  v_permlane16_swap_b32 v133, v135
  buffer_store_dwordx4 v[132:135], v128, s[28:31], s52 offen
  v_cvt_pk_bf16_f32 v6, v56, v57
  v_cvt_pk_bf16_f32 v7, v58, v59
  v_lshlrev_b32 v56, 16, v6
  v_and_b32 v57, 0xffff0000, v6
  v_lshlrev_b32 v58, 16, v7
  v_and_b32 v59, 0xffff0000, v7
  v_lshlrev_b32 v6, 16, v20
  v_and_b32 v7, 0xffff0000, v20
  v_lshlrev_b32 v8, 16, v21
  v_and_b32 v9, 0xffff0000, v21
  v_add_f32 v56, v56, v6
  v_add_f32 v57, v57, v7
  v_add_f32 v58, v58, v8
  v_add_f32 v59, v59, v9
  v_cvt_pk_bf16_f32 v136, v56, v57
  v_cvt_pk_bf16_f32 v137, v58, v59
  v_cvt_pk_bf16_f32 v6, v60, v61
  v_cvt_pk_bf16_f32 v7, v62, v63
  v_lshlrev_b32 v60, 16, v6
  v_and_b32 v61, 0xffff0000, v6
  v_lshlrev_b32 v62, 16, v7
  v_and_b32 v63, 0xffff0000, v7
  v_lshlrev_b32 v6, 16, v22
  v_and_b32 v7, 0xffff0000, v22
  v_lshlrev_b32 v8, 16, v23
  v_and_b32 v9, 0xffff0000, v23
  v_add_f32 v60, v60, v6
  v_add_f32 v61, v61, v7
  v_add_f32 v62, v62, v8
  v_add_f32 v63, v63, v9
  v_cvt_pk_bf16_f32 v138, v60, v61
  v_cvt_pk_bf16_f32 v139, v62, v63
  s_nop 0
  v_permlane16_swap_b32 v136, v138
  v_permlane16_swap_b32 v137, v139
  buffer_store_dwordx4 v[136:139], v128, s[28:31], s52 offen offset:1024
  s_endpgm
L_PROD:
  v_lshrrev_b32 v6, 3, v2
  v_and_b32 v7, 7, v2
  v_lshrrev_b32 v8, 1, v6
  v_xor_b32 v8, v7, v8
  v_lshlrev_b32 v8, 4, v8
  v_lshl_add_u32 v24, v6, 11, v8
  v_xor_b32 v25, 64, v24
  v_and_b32 v8, 2, v6
  v_xor_b32 v8, v7, v8
  v_lshlrev_b32 v8, 4, v8
  v_mul_u32_u24 v9, 3072, v6
  v_add_u32 v26, v9, v8
  v_xor_b32 v27, 64, v26
  s_lshl_b32 s58, s4, 6
  s_add_u32 s59, s58, 0
  v_xor_b32 v28, s59, v5
  v_lshl_add_u32 v28, s5, 7, v28
  v_and_b32 v28, 1023, v28
  s_add_u32 s59, s58, 16
  v_xor_b32 v29, s59, v5
  v_lshl_add_u32 v29, s5, 7, v29
  v_and_b32 v29, 1023, v29
  s_add_u32 s59, s58, 32
  v_xor_b32 v30, s59, v5
  v_lshl_add_u32 v30, s5, 7, v30
  v_and_b32 v30, 1023, v30
  s_add_u32 s59, s58, 48
  v_xor_b32 v31, s59, v5
  v_lshl_add_u32 v31, s5, 7, v31
  v_and_b32 v31, 1023, v31
  v_and_b32 v8, 6, v6
  v_xor_b32 v7, v7, v8
  v_lshlrev_b32 v7, 4, v7
  v_lshl_add_u32 v32, v6, 10, v7
  v_add_u32 v6, 0, v2
  v_mul_u32_u24 v7, 171, v6
  v_lshrrev_b32 v7, 11, v7
  v_mul_u32_u24 v8, 12, v7
  v_sub_u32 v8, v6, v8
  v_bfe_u32 v9, v7, 2, 1
  v_lshlrev_b32 v9, 1, v9
  v_xor_b32 v8, v8, v9
  v_lshlrev_b32 v8, 4, v8
  v_mul_u32_u24 v7, 2752, v7
  v_add_u32 v33, v7, v8
  v_add_u32 v6, 64, v2
  v_mul_u32_u24 v7, 171, v6
  v_lshrrev_b32 v7, 11, v7
  v_mul_u32_u24 v8, 12, v7
  v_sub_u32 v8, v6, v8
  v_bfe_u32 v9, v7, 2, 1
  v_lshlrev_b32 v9, 1, v9
  v_xor_b32 v8, v8, v9
  v_lshlrev_b32 v8, 4, v8
  v_mul_u32_u24 v7, 2752, v7
  v_add_u32 v34, v7, v8
  v_add_u32 v6, 128, v2
  v_mul_u32_u24 v7, 171, v6
  v_lshrrev_b32 v7, 11, v7
  v_mul_u32_u24 v8, 12, v7
  v_sub_u32 v8, v6, v8
  v_bfe_u32 v9, v7, 2, 1
  v_lshlrev_b32 v9, 1, v9
  v_xor_b32 v8, v8, v9
  v_lshlrev_b32 v8, 4, v8
  v_mul_u32_u24 v7, 2752, v7
  v_add_u32 v35, v7, v8
  v_lshlrev_b32 v36, 2, v2
  v_mov_b32 v39, 0
  s_lshl_b32 s60, s4, 10
  s_lshl_b32 s61, s4, 11
  s_mul_i32 s62, s4, 3072
  s_lshl_b32 s63, s4, 12
  s_lshr_b32 s40, s6, 3
  s_lshl_b32 s41, s5, 2
  s_add_u32 s40, s40, s41
  s_and_b32 s41, s6, 7
  s_lshr_b32 s42, s40, 1
  s_and_b32 s43, s6, 15
  s_lshl_b32 s58, s6, 13
  v_lshlrev_b32 v40, 7, v2
  v_add_u32 v40, s58, v40
  s_lshl_b32 s58, s40, 16
  s_lshr_b32 s59, s4, 1
  s_lshl_b32 s59, s59, 15
  s_add_u32 s64, s58, s59
  s_and_b32 s59, s4, 1
  s_lshl_b32 s59, s59, 10
  s_add_u32 s64, s64, s59
  s_add_u32 s65, s64, 16384
  s_mul_i32 s66, s4, 49152
  s_lshl_b32 s59, s41, 7
  s_add_u32 s66, s66, s59
  s_lshl_b32 s67, s4, 13
  s_add_u32 s68, s67, s59
  s_add_u32 s67, s67, s58
  s_cmp_lt_u32 s4, 2
  s_cselect_b32 s59, 16, 31
  s_lshl_b32 s59, s59, 10
  s_sub_u32 s67, s67, s59
  s_lshl_b32 s59, s4, 14
  s_add_u32 s69, s58, s59
  s_mul_i32 s59, s42, 221184
  s_add_u32 s69, s69, s59
  s_add_u32 s69, s69, 4194304
  s_mul_i32 s70, s4, 44032
  s_mul_i32 s59, s43, 192
  s_add_u32 s70, s70, s59
  s_lshl_b32 s71, s42, 17
  s_lshl_b32 s59, s4, 15
  s_add_u32 s71, s71, s59
  s_mul_i32 s59, s42, 221184
  s_add_u32 s71, s71, s59
  s_add_u32 s71, s71, 4325376
  s_lshl_b32 s72, s40, 2
  s_add_u32 s72, s72, s4
  s_mul_i32 s72, s72, 44032
  s_add_u32 s72, s72, 4194304
  s_mul_i32 s84, s5, 65536
  s_mul_i32 s85, s5, 2048
  s_mul_i32 s86, s5, 176128
  s_mul_i32 s87, s5, 2048
  s_mul_i32 s88, s5, 163840
  s_mul_i32 s89, s5, 5120
  s_cmp_eq_u32 s4, 0
  s_cselect_b32 s58, 162816, s63
  s_add_u32 s73, s67, 0
  s_mov_b32 m0, s58
  s_nop 0
  buffer_load_dwordx4 v28, s[8:11], s73 offen lds
  s_add_u32 s73, s67, 2048
  s_add_u32 m0, s63, 1024
  s_nop 0
  buffer_load_dwordx4 v29, s[8:11], s73 offen lds
  s_add_u32 s73, s67, 4096
  s_add_u32 m0, s63, 2048
  s_nop 0
  buffer_load_dwordx4 v30, s[8:11], s73 offen lds
  s_add_u32 s73, s67, 6144
  s_add_u32 m0, s63, 3072
  s_nop 0
  buffer_load_dwordx4 v31, s[8:11], s73 offen lds
  s_add_u32 s58, s5, 0
  s_and_b32 s58, s58, 7
  s_lshl_b32 s59, s58, 7
  s_mul_i32 s58, s58, 196608
  s_add_u32 s73, s64, s59
  s_add_u32 m0, s61, 16384
  s_nop 0
  buffer_load_dwordx4 v24, s[8:11], s73 offen lds
  s_add_u32 s73, s65, s59
  s_add_u32 m0, s61, 17408
  s_nop 0
  buffer_load_dwordx4 v25, s[8:11], s73 offen lds
  s_add_u32 s73, s66, s58
  s_add_u32 m0, s61, 24576
  s_nop 0
  buffer_load_dwordx4 v26, s[12:15], s73 offen lds
  s_add_u32 m0, s61, 31744
  s_nop 0
  buffer_load_dwordx4 v26, s[12:15], s73 offen offset:1024 lds
  s_add_u32 m0, s61, 38912
  s_nop 0
  buffer_load_dwordx4 v26, s[12:15], s73 offen offset:2048 lds
  s_add_u32 s73, s73, 24576
  s_add_u32 m0, s61, 25600
  s_nop 0
  buffer_load_dwordx4 v27, s[12:15], s73 offen lds
  s_add_u32 m0, s61, 32768
  s_nop 0
  buffer_load_dwordx4 v27, s[12:15], s73 offen offset:1024 lds
  s_add_u32 m0, s61, 39936
  s_nop 0
  buffer_load_dwordx4 v27, s[12:15], s73 offen offset:2048 lds
  s_add_u32 s58, s5, 1
  s_and_b32 s58, s58, 7
  s_lshl_b32 s59, s58, 7
  s_mul_i32 s58, s58, 196608
  s_add_u32 s73, s64, s59
  s_add_u32 m0, s61, 49152
  s_nop 0
  buffer_load_dwordx4 v24, s[8:11], s73 offen lds
  s_add_u32 s73, s65, s59
  s_add_u32 m0, s61, 50176
  s_nop 0
  buffer_load_dwordx4 v25, s[8:11], s73 offen lds
  s_add_u32 s73, s66, s58
  s_add_u32 m0, s61, 57344
  s_nop 0
  buffer_load_dwordx4 v26, s[12:15], s73 offen lds
  s_add_u32 m0, s61, 64512
  s_nop 0
  buffer_load_dwordx4 v26, s[12:15], s73 offen offset:1024 lds
  s_add_u32 m0, s61, 71680
  s_nop 0
  buffer_load_dwordx4 v26, s[12:15], s73 offen offset:2048 lds
  s_add_u32 s73, s73, 24576
  s_add_u32 m0, s61, 58368
  s_nop 0
  buffer_load_dwordx4 v27, s[12:15], s73 offen lds
  s_add_u32 m0, s61, 65536
  s_nop 0
  buffer_load_dwordx4 v27, s[12:15], s73 offen offset:1024 lds
  s_add_u32 m0, s61, 72704
  s_nop 0
  buffer_load_dwordx4 v27, s[12:15], s73 offen offset:2048 lds
  s_waitcnt vmcnt(8)
  s_barrier
  s_add_u32 s58, s5, 2
  s_and_b32 s58, s58, 7
  s_lshl_b32 s59, s58, 7
  s_mul_i32 s58, s58, 196608
  s_add_u32 s73, s64, s59
  s_add_u32 m0, s61, 81920
  s_nop 0
  buffer_load_dwordx4 v24, s[8:11], s73 offen lds
  s_add_u32 s73, s65, s59
  s_add_u32 m0, s61, 82944
  s_nop 0
  buffer_load_dwordx4 v25, s[8:11], s73 offen lds
  s_add_u32 s73, s66, s58
  s_add_u32 m0, s61, 90112
  s_nop 0
  buffer_load_dwordx4 v26, s[12:15], s73 offen lds
  s_add_u32 m0, s61, 97280
  s_nop 0
  buffer_load_dwordx4 v26, s[12:15], s73 offen offset:1024 lds
  s_add_u32 m0, s61, 104448
  s_nop 0
  buffer_load_dwordx4 v26, s[12:15], s73 offen offset:2048 lds
  s_add_u32 s73, s73, 24576
  s_add_u32 m0, s61, 91136
  s_nop 0
  buffer_load_dwordx4 v27, s[12:15], s73 offen lds
  s_add_u32 m0, s61, 98304
  s_nop 0
  buffer_load_dwordx4 v27, s[12:15], s73 offen offset:1024 lds
  s_add_u32 m0, s61, 105472
  s_nop 0
  buffer_load_dwordx4 v27, s[12:15], s73 offen offset:2048 lds
  s_cmp_lg_u32 s4, 0
  s_cbranch_scc1 L_T1_0
  s_add_u32 s58, s5, 4
  s_and_b32 s58, s58, 7
  s_mul_i32 s58, s58, 196608
  s_add_u32 s58, s58, 0
  v_add_u32 v42, s58, v40
  v_subrev_u32 v41, 0x180000, v42
  v_min_u32 v42, v42, v41
  buffer_load_dword v41, v42, s[12:15], 0 offen
  s_branch L_T1_E
L_T1_0:
  s_cmp_lg_u32 s4, 1
  s_cbranch_scc1 L_T1_1
  s_add_u32 s58, s5, 4
  s_and_b32 s58, s58, 7
  s_mul_i32 s58, s58, 196608
  s_add_u32 s58, s58, 262144
  v_add_u32 v42, s58, v40
  v_subrev_u32 v41, 0x180000, v42
  v_min_u32 v42, v42, v41
  buffer_load_dword v41, v42, s[12:15], 0 offen
  s_branch L_T1_E
L_T1_1:
  s_cmp_lg_u32 s4, 2
  s_cbranch_scc1 L_T1_2
  s_add_u32 s58, s5, 4
  s_and_b32 s58, s58, 7
  s_mul_i32 s58, s58, 196608
  s_add_u32 s58, s58, 524288
  v_add_u32 v42, s58, v40
  v_subrev_u32 v41, 0x180000, v42
  v_min_u32 v42, v42, v41
  buffer_load_dword v41, v42, s[12:15], 0 offen
  s_branch L_T1_E
L_T1_2:
  s_mul_i32 s58, s5, 262144
  s_add_u32 s58, s58, 0
  buffer_load_dword v41, v40, s[8:11], s58 offen
L_T1_E:
  s_waitcnt vmcnt(9)
  s_barrier
  s_add_u32 s58, s5, 3
  s_and_b32 s58, s58, 7
  s_lshl_b32 s59, s58, 7
  s_mul_i32 s58, s58, 196608
  s_add_u32 s73, s64, s59
  s_add_u32 m0, s61, 16384
  s_nop 0
  buffer_load_dwordx4 v24, s[8:11], s73 offen lds
  s_add_u32 s73, s65, s59
  s_add_u32 m0, s61, 17408
  s_nop 0
  buffer_load_dwordx4 v25, s[8:11], s73 offen lds
  s_add_u32 s73, s66, s58
  s_add_u32 m0, s61, 24576
  s_nop 0
  buffer_load_dwordx4 v26, s[12:15], s73 offen lds
  s_add_u32 m0, s61, 31744
  s_nop 0
  buffer_load_dwordx4 v26, s[12:15], s73 offen offset:1024 lds
  s_add_u32 m0, s61, 38912
  s_nop 0
  buffer_load_dwordx4 v26, s[12:15], s73 offen offset:2048 lds
  s_add_u32 s73, s73, 24576
  s_add_u32 m0, s61, 25600
  s_nop 0
  buffer_load_dwordx4 v27, s[12:15], s73 offen lds
  s_add_u32 m0, s61, 32768
  s_nop 0
  buffer_load_dwordx4 v27, s[12:15], s73 offen offset:1024 lds
  s_add_u32 m0, s61, 39936
  s_nop 0
  buffer_load_dwordx4 v27, s[12:15], s73 offen offset:2048 lds
  s_waitcnt vmcnt(9)
  s_barrier
  s_add_u32 s58, s5, 4
  s_and_b32 s58, s58, 7
  s_lshl_b32 s59, s58, 7
  s_mul_i32 s58, s58, 196608
  s_add_u32 s73, s64, s59
  s_add_u32 m0, s61, 49152
  s_nop 0
  buffer_load_dwordx4 v24, s[8:11], s73 offen lds
  s_add_u32 s73, s65, s59
  s_add_u32 m0, s61, 50176
  s_nop 0
  buffer_load_dwordx4 v25, s[8:11], s73 offen lds
  s_add_u32 s73, s66, s58
  s_add_u32 m0, s61, 57344
  s_nop 0
  buffer_load_dwordx4 v26, s[12:15], s73 offen lds
  s_add_u32 m0, s61, 64512
  s_nop 0
  buffer_load_dwordx4 v26, s[12:15], s73 offen offset:1024 lds
  s_add_u32 m0, s61, 71680
  s_nop 0
  buffer_load_dwordx4 v26, s[12:15], s73 offen offset:2048 lds
  s_add_u32 s73, s73, 24576
  s_add_u32 m0, s61, 58368
  s_nop 0
  buffer_load_dwordx4 v27, s[12:15], s73 offen lds
  s_add_u32 m0, s61, 65536
  s_nop 0
  buffer_load_dwordx4 v27, s[12:15], s73 offen offset:1024 lds
  s_add_u32 m0, s61, 72704
  s_nop 0
  buffer_load_dwordx4 v27, s[12:15], s73 offen offset:2048 lds
  s_waitcnt vmcnt(8)
  s_barrier
  s_add_u32 s58, s5, 5
  s_and_b32 s58, s58, 7
  s_lshl_b32 s59, s58, 7
  s_mul_i32 s58, s58, 196608
  s_add_u32 s73, s64, s59
  s_add_u32 m0, s61, 81920
  s_nop 0
  buffer_load_dwordx4 v24, s[8:11], s73 offen lds
  s_add_u32 s73, s65, s59
  s_add_u32 m0, s61, 82944
  s_nop 0
  buffer_load_dwordx4 v25, s[8:11], s73 offen lds
  s_add_u32 s73, s66, s58
  s_add_u32 m0, s61, 90112
  s_nop 0
  buffer_load_dwordx4 v26, s[12:15], s73 offen lds
  s_add_u32 m0, s61, 97280
  s_nop 0
  buffer_load_dwordx4 v26, s[12:15], s73 offen offset:1024 lds
  s_add_u32 m0, s61, 104448
  s_nop 0
  buffer_load_dwordx4 v26, s[12:15], s73 offen offset:2048 lds
  s_add_u32 s73, s73, 24576
  s_add_u32 m0, s61, 91136
  s_nop 0
  buffer_load_dwordx4 v27, s[12:15], s73 offen lds
  s_add_u32 m0, s61, 98304
  s_nop 0
  buffer_load_dwordx4 v27, s[12:15], s73 offen offset:1024 lds
  s_add_u32 m0, s61, 105472
  s_nop 0
  buffer_load_dwordx4 v27, s[12:15], s73 offen offset:2048 lds
  s_waitcnt vmcnt(8)
  s_barrier
  s_add_u32 s58, s5, 6
  s_and_b32 s58, s58, 7
  s_lshl_b32 s59, s58, 7
  s_mul_i32 s58, s58, 196608
  s_add_u32 s73, s64, s59
  s_add_u32 m0, s61, 16384
  s_nop 0
  buffer_load_dwordx4 v24, s[8:11], s73 offen lds
  s_add_u32 s73, s65, s59
  s_add_u32 m0, s61, 17408
  s_nop 0
  buffer_load_dwordx4 v25, s[8:11], s73 offen lds
  s_add_u32 s73, s66, s58
  s_add_u32 m0, s61, 24576
  s_nop 0
  buffer_load_dwordx4 v26, s[12:15], s73 offen lds
  s_add_u32 m0, s61, 31744
  s_nop 0
  buffer_load_dwordx4 v26, s[12:15], s73 offen offset:1024 lds
  s_add_u32 m0, s61, 38912
  s_nop 0
  buffer_load_dwordx4 v26, s[12:15], s73 offen offset:2048 lds
  s_add_u32 s73, s73, 24576
  s_add_u32 m0, s61, 25600
  s_nop 0
  buffer_load_dwordx4 v27, s[12:15], s73 offen lds
  s_add_u32 m0, s61, 32768
  s_nop 0
  buffer_load_dwordx4 v27, s[12:15], s73 offen offset:1024 lds
  s_add_u32 m0, s61, 39936
  s_nop 0
  buffer_load_dwordx4 v27, s[12:15], s73 offen offset:2048 lds
  s_cmp_lg_u32 s4, 0
  s_cbranch_scc1 L_T2_0
  s_mul_i32 s58, s5, 65536
  s_add_u32 s58, s58, 0
  v_add_u32 v42, s58, v40
  v_subrev_u32 v41, 524288, v42
  v_min_u32 v42, v42, v41
  buffer_load_dword v41, v42, s[16:19], 0 offen
  s_branch L_T2_E
L_T2_0:
  s_cmp_lg_u32 s4, 1
  s_cbranch_scc1 L_T2_1
  s_mul_i32 s58, s5, 65536
  s_add_u32 s58, s58, 262144
  v_add_u32 v42, s58, v40
  v_subrev_u32 v41, 524288, v42
  v_min_u32 v42, v42, v41
  buffer_load_dword v41, v42, s[16:19], 0 offen
  s_branch L_T2_E
L_T2_1:
  s_cmp_lg_u32 s4, 2
  s_cbranch_scc1 L_T2_2
  s_mov_b32 s58, 2130706432
  buffer_load_dword v41, v40, s[24:27], s58 offen
  s_branch L_T2_E
L_T2_2:
  s_mov_b32 s58, 2130706432
  buffer_load_dword v41, v40, s[24:27], s58 offen
L_T2_E:
  s_waitcnt vmcnt(9)
  s_barrier
  s_add_u32 s58, s5, 7
  s_and_b32 s58, s58, 7
  s_lshl_b32 s59, s58, 7
  s_mul_i32 s58, s58, 196608
  s_add_u32 s73, s64, s59
  s_add_u32 m0, s61, 49152
  s_nop 0
  buffer_load_dwordx4 v24, s[8:11], s73 offen lds
  s_add_u32 s73, s65, s59
  s_add_u32 m0, s61, 50176
  s_nop 0
  buffer_load_dwordx4 v25, s[8:11], s73 offen lds
  s_add_u32 s73, s66, s58
  s_add_u32 m0, s61, 57344
  s_nop 0
  buffer_load_dwordx4 v26, s[12:15], s73 offen lds
  s_add_u32 m0, s61, 64512
  s_nop 0
  buffer_load_dwordx4 v26, s[12:15], s73 offen offset:1024 lds
  s_add_u32 m0, s61, 71680
  s_nop 0
  buffer_load_dwordx4 v26, s[12:15], s73 offen offset:2048 lds
  s_add_u32 s73, s73, 24576
  s_add_u32 m0, s61, 58368
  s_nop 0
  buffer_load_dwordx4 v27, s[12:15], s73 offen lds
  s_add_u32 m0, s61, 65536
  s_nop 0
  buffer_load_dwordx4 v27, s[12:15], s73 offen offset:1024 lds
  s_add_u32 m0, s61, 72704
  s_nop 0
  buffer_load_dwordx4 v27, s[12:15], s73 offen offset:2048 lds
  s_waitcnt vmcnt(9)
  s_barrier
  s_cmp_lg_u32 s4, 0
  s_cbranch_scc1 L_T3_0
  s_cmp_lt_u32 s6, 16
  s_cselect_b32 s59, 0, 221184
  s_mul_i32 s58, s5, 704512
  s_add_u32 s58, s58, s59
  s_add_u32 s58, s58, 4194304
  buffer_load_dword v41, v40, s[36:39], s58 offen sc1
  s_branch L_T3_E
L_T3_0:
  s_cmp_lg_u32 s4, 1
  s_cbranch_scc1 L_T3_1
  s_cmp_lt_u32 s6, 16
  s_cselect_b32 s59, 0, 221184
  s_mul_i32 s58, s5, 704512
  s_add_u32 s58, s58, s59
  s_add_u32 s58, s58, 4325376
  buffer_load_dword v41, v40, s[36:39], s58 offen sc1
  s_branch L_T3_E
L_T3_1:
  s_cmp_lg_u32 s4, 2
  s_cbranch_scc1 L_T3_2
  s_mov_b32 s58, 2130706432
  buffer_load_dword v41, v40, s[24:27], s58 offen
  s_branch L_T3_E
L_T3_2:
  s_mov_b32 s58, 2130706432
  buffer_load_dword v41, v40, s[24:27], s58 offen
L_T3_E:
  s_waitcnt vmcnt(1)
  s_barrier
  s_barrier
  s_cmp_lg_u32 s4, 0
  s_cbranch_scc1 L_T4_0
  s_mul_i32 s58, s5, 176128
  s_add_u32 s58, s58, 352256
  v_add_u32 v42, s58, v40
  v_subrev_u32 v41, 1409024, v42
  v_min_u32 v42, v42, v41
  buffer_load_dword v41, v42, s[20:23], 0 offen
  s_branch L_T4_E
L_T4_0:
  s_cmp_lg_u32 s4, 1
  s_cbranch_scc1 L_T4_1
  s_mul_i32 s58, s5, 176128
  s_add_u32 s58, s58, 614400
  v_add_u32 v42, s58, v40
  v_subrev_u32 v41, 1409024, v42
  v_min_u32 v42, v42, v41
  buffer_load_dword v41, v42, s[20:23], 0 offen
  s_branch L_T4_E
L_T4_1:
  s_cmp_lg_u32 s4, 2
  s_cbranch_scc1 L_T4_2
  s_mov_b32 s58, 2130706432
  buffer_load_dword v41, v40, s[24:27], s58 offen
  s_branch L_T4_E
L_T4_2:
  s_mov_b32 s58, 2130706432
  buffer_load_dword v41, v40, s[24:27], s58 offen
L_T4_E:
  s_add_u32 s73, s68, s84
  s_add_u32 m0, s60, 157696
  s_nop 0
  buffer_load_dwordx4 v32, s[16:19], s73 offen lds
  s_add_u32 s84, s84, 32768
  s_cmp_eq_u32 s84, 524288
  s_cselect_b32 s84, 0, s84
  s_add_u32 s73, s68, s84
  s_add_u32 m0, s60, 153600
  s_nop 0
  buffer_load_dwordx4 v32, s[16:19], s73 offen lds
  s_add_u32 s84, s84, 32768
  s_cmp_eq_u32 s84, 524288
  s_cselect_b32 s84, 0, s84
  s_add_u32 s73, s68, s84
  s_add_u32 m0, s60, 149504
  s_nop 0
  buffer_load_dwordx4 v32, s[16:19], s73 offen lds
  s_add_u32 s84, s84, 32768
  s_cmp_eq_u32 s84, 524288
  s_cselect_b32 s84, 0, s84
  s_add_u32 s73, s68, s84
  s_add_u32 m0, s60, 145408
  s_nop 0
  buffer_load_dwordx4 v32, s[16:19], s73 offen lds
  s_add_u32 s84, s84, 32768
  s_cmp_eq_u32 s84, 524288
  s_cselect_b32 s84, 0, s84
  s_add_u32 s73, s68, s84
  s_add_u32 m0, s60, 141312
  s_nop 0
  buffer_load_dwordx4 v32, s[16:19], s73 offen lds
  s_add_u32 s84, s84, 32768
  s_cmp_eq_u32 s84, 524288
  s_cselect_b32 s84, 0, s84
  s_add_u32 s73, s68, s84
  s_add_u32 m0, s60, 137216
  s_nop 0
  buffer_load_dwordx4 v32, s[16:19], s73 offen lds
  s_add_u32 s84, s84, 32768
  s_cmp_eq_u32 s84, 524288
  s_cselect_b32 s84, 0, s84
  s_add_u32 s73, s68, s84
  s_add_u32 m0, s60, 133120
  s_nop 0
  buffer_load_dwordx4 v32, s[16:19], s73 offen lds
  s_add_u32 s84, s84, 32768
  s_cmp_eq_u32 s84, 524288
  s_cselect_b32 s84, 0, s84
  s_add_u32 s73, s68, s84
  s_add_u32 m0, s60, 129024
  s_nop 0
  buffer_load_dwordx4 v32, s[16:19], s73 offen lds
  s_add_u32 s84, s84, 32768
  s_cmp_eq_u32 s84, 524288
  s_cselect_b32 s84, 0, s84
  s_add_u32 s73, s68, s84
  s_add_u32 m0, s60, 124928
  s_nop 0
  buffer_load_dwordx4 v32, s[16:19], s73 offen lds
  s_add_u32 s84, s84, 32768
  s_cmp_eq_u32 s84, 524288
  s_cselect_b32 s84, 0, s84
  s_add_u32 s73, s68, s84
  s_add_u32 m0, s60, 120832
  s_nop 0
  buffer_load_dwordx4 v32, s[16:19], s73 offen lds
  s_add_u32 s84, s84, 32768
  s_cmp_eq_u32 s84, 524288
  s_cselect_b32 s84, 0, s84
  s_add_u32 s73, s68, s84
  s_add_u32 m0, s60, 116736
  s_nop 0
  buffer_load_dwordx4 v32, s[16:19], s73 offen lds
  s_add_u32 s84, s84, 32768
  s_cmp_eq_u32 s84, 524288
  s_cselect_b32 s84, 0, s84
  s_add_u32 s73, s68, s84
  s_add_u32 m0, s60, 112640
  s_nop 0
  buffer_load_dwordx4 v32, s[16:19], s73 offen lds
  s_add_u32 s84, s84, 32768
  s_cmp_eq_u32 s84, 524288
  s_cselect_b32 s84, 0, s84
  s_add_u32 s73, s68, s84
  s_add_u32 m0, s60, 108544
  s_nop 0
  buffer_load_dwordx4 v32, s[16:19], s73 offen lds
  s_add_u32 s84, s84, 32768
  s_cmp_eq_u32 s84, 524288
  s_cselect_b32 s84, 0, s84
  s_add_u32 s73, s68, s84
  s_add_u32 m0, s60, 104448
  s_nop 0
  buffer_load_dwordx4 v32, s[16:19], s73 offen lds
  s_add_u32 s84, s84, 32768
  s_cmp_eq_u32 s84, 524288
  s_cselect_b32 s84, 0, s84
  s_add_u32 s73, s68, s84
  s_add_u32 m0, s60, 100352
  s_nop 0
  buffer_load_dwordx4 v32, s[16:19], s73 offen lds
  s_add_u32 s84, s84, 32768
  s_cmp_eq_u32 s84, 524288
  s_cselect_b32 s84, 0, s84
  s_add_u32 s73, s68, s84
  s_add_u32 m0, s60, 96256
  s_nop 0
  buffer_load_dwordx4 v32, s[16:19], s73 offen lds
  s_add_u32 s84, s84, 32768
  s_cmp_eq_u32 s84, 524288
  s_cselect_b32 s84, 0, s84
  s_add_u32 s73, s70, s86
  s_add_u32 m0, s62, 83968
  s_nop 0
  buffer_load_dwordx4 v33, s[20:23], s73 offen lds
  s_add_u32 m0, s62, 84992
  s_nop 0
  buffer_load_dwordx4 v34, s[20:23], s73 offen lds
  s_add_u32 m0, s62, 86016
  s_nop 0
  buffer_load_dwordx4 v35, s[20:23], s73 offen lds
  s_add_u32 s86, s86, 176128
  s_cmp_eq_u32 s86, 1409024
  s_cselect_b32 s86, 0, s86
  s_add_u32 s73, s70, s86
  s_add_u32 m0, s62, 71680
  s_nop 0
  buffer_load_dwordx4 v33, s[20:23], s73 offen lds
  s_add_u32 m0, s62, 72704
  s_nop 0
  buffer_load_dwordx4 v34, s[20:23], s73 offen lds
  s_add_u32 m0, s62, 73728
  s_nop 0
  buffer_load_dwordx4 v35, s[20:23], s73 offen lds
  s_add_u32 s86, s86, 176128
  s_cmp_eq_u32 s86, 1409024
  s_cselect_b32 s86, 0, s86
  v_mov_b32 v6, 162688
  ds_read_b32 v6, v6
  s_waitcnt lgkmcnt(0)
  v_readfirstlane_b32 s58, v6
  s_nop 0
  s_cmp_lg_u32 s58, 0
  s_cbranch_scc1 L_FIX
  s_mul_i32 s75, s5, 2048
  s_add_u32 s75, s75, 9961472
  s_and_b32 s59, s6, 24
  s_lshl_b32 s59, s59, 4
  s_add_u32 s75, s75, s59
  s_mov_b32 s58, 0
  s_mov_b32 s76, -1
  s_mov_b32 s77, 0x0
  s_mov_b64 exec, s[76:77]
L_P_POLLA:
  buffer_load_dword v37, v36, s[36:39], s75 offen sc1
  s_waitcnt vmcnt(0)
  v_cmp_ne_u32 vcc, 1, v37
  s_add_u32 s58, s58, 1
  s_cmp_gt_u32 s58, 20000
  s_cbranch_scc1 L_P_POLLA_OK
  s_cbranch_vccnz L_P_POLLA
L_P_POLLA_OK:
  s_mov_b64 exec, -1
  s_add_u32 s73, s69, s85
  s_add_u32 m0, s60, 0
  s_nop 0
  buffer_load_dwordx4 v5, s[36:39], s73 offen sc1 lds
  s_add_u32 s85, s85, 1024
  s_cmp_eq_u32 s85, 16384
  s_cselect_b32 s85, 0, s85
  s_add_u32 s73, s69, s85
  s_add_u32 m0, s60, 4096
  s_nop 0
  buffer_load_dwordx4 v5, s[36:39], s73 offen sc1 lds
  s_add_u32 s85, s85, 1024
  s_cmp_eq_u32 s85, 16384
  s_cselect_b32 s85, 0, s85
  s_add_u32 s73, s69, s85
  s_add_u32 m0, s60, 8192
  s_nop 0
  buffer_load_dwordx4 v5, s[36:39], s73 offen sc1 lds
  s_add_u32 s85, s85, 1024
  s_cmp_eq_u32 s85, 16384
  s_cselect_b32 s85, 0, s85
  s_add_u32 s73, s69, s85
  s_add_u32 m0, s60, 12288
  s_nop 0
  buffer_load_dwordx4 v5, s[36:39], s73 offen sc1 lds
  s_add_u32 s85, s85, 1024
  s_cmp_eq_u32 s85, 16384
  s_cselect_b32 s85, 0, s85
  s_add_u32 s73, s69, s85
  s_add_u32 m0, s60, 16384
  s_nop 0
  buffer_load_dwordx4 v5, s[36:39], s73 offen sc1 lds
  s_add_u32 s85, s85, 1024
  s_cmp_eq_u32 s85, 16384
  s_cselect_b32 s85, 0, s85
  s_add_u32 s73, s69, s85
  s_add_u32 m0, s60, 20480
  s_nop 0
  buffer_load_dwordx4 v5, s[36:39], s73 offen sc1 lds
  s_add_u32 s85, s85, 1024
  s_cmp_eq_u32 s85, 16384
  s_cselect_b32 s85, 0, s85
  s_add_u32 s73, s69, s85
  s_add_u32 m0, s60, 24576
  s_nop 0
  buffer_load_dwordx4 v5, s[36:39], s73 offen sc1 lds
  s_add_u32 s85, s85, 1024
  s_cmp_eq_u32 s85, 16384
  s_cselect_b32 s85, 0, s85
  s_add_u32 s73, s69, s85
  s_add_u32 m0, s60, 28672
  s_nop 0
  buffer_load_dwordx4 v5, s[36:39], s73 offen sc1 lds
  s_add_u32 s85, s85, 1024
  s_cmp_eq_u32 s85, 16384
  s_cselect_b32 s85, 0, s85
  s_waitcnt vmcnt(6)
  s_barrier
  s_add_u32 s73, s69, s85
  s_add_u32 m0, s60, 32768
  s_nop 0
  buffer_load_dwordx4 v5, s[36:39], s73 offen sc1 lds
  s_add_u32 s85, s85, 1024
  s_cmp_eq_u32 s85, 16384
  s_cselect_b32 s85, 0, s85
  s_add_u32 s73, s69, s85
  s_add_u32 m0, s60, 36864
  s_nop 0
  buffer_load_dwordx4 v5, s[36:39], s73 offen sc1 lds
  s_add_u32 s85, s85, 1024
  s_cmp_eq_u32 s85, 16384
  s_cselect_b32 s85, 0, s85
  s_add_u32 s73, s69, s85
  s_add_u32 m0, s60, 40960
  s_nop 0
  buffer_load_dwordx4 v5, s[36:39], s73 offen sc1 lds
  s_add_u32 s85, s85, 1024
  s_cmp_eq_u32 s85, 16384
  s_cselect_b32 s85, 0, s85
  s_add_u32 s73, s69, s85
  s_add_u32 m0, s60, 45056
  s_nop 0
  buffer_load_dwordx4 v5, s[36:39], s73 offen sc1 lds
  s_add_u32 s85, s85, 1024
  s_cmp_eq_u32 s85, 16384
  s_cselect_b32 s85, 0, s85
  s_add_u32 s73, s69, s85
  s_add_u32 m0, s60, 49152
  s_nop 0
  buffer_load_dwordx4 v5, s[36:39], s73 offen sc1 lds
  s_add_u32 s85, s85, 1024
  s_cmp_eq_u32 s85, 16384
  s_cselect_b32 s85, 0, s85
  s_add_u32 s73, s69, s85
  s_add_u32 m0, s60, 53248
  s_nop 0
  buffer_load_dwordx4 v5, s[36:39], s73 offen sc1 lds
  s_add_u32 s85, s85, 1024
  s_cmp_eq_u32 s85, 16384
  s_cselect_b32 s85, 0, s85
  s_add_u32 s73, s69, s85
  s_add_u32 m0, s60, 57344
  s_nop 0
  buffer_load_dwordx4 v5, s[36:39], s73 offen sc1 lds
  s_add_u32 s85, s85, 1024
  s_cmp_eq_u32 s85, 16384
  s_cselect_b32 s85, 0, s85
  s_add_u32 s73, s69, s85
  s_add_u32 m0, s60, 61440
  s_nop 0
  buffer_load_dwordx4 v5, s[36:39], s73 offen sc1 lds
  s_add_u32 s85, s85, 1024
  s_cmp_eq_u32 s85, 16384
  s_cselect_b32 s85, 0, s85
  s_cmp_lg_u32 s4, 0
  s_cbranch_scc1 L_T5_0
  s_mul_i32 s58, s5, 176128
  s_add_u32 s58, s58, 876544
  v_add_u32 v42, s58, v40
  v_subrev_u32 v41, 1409024, v42
  v_min_u32 v42, v42, v41
  buffer_load_dword v41, v42, s[20:23], 0 offen
  s_branch L_T5_E
L_T5_0:
  s_cmp_lg_u32 s4, 1
  s_cbranch_scc1 L_T5_1
  s_mul_i32 s58, s5, 176128
  s_add_u32 s58, s58, 1138688
  v_add_u32 v42, s58, v40
  v_subrev_u32 v41, 1409024, v42
  v_min_u32 v42, v42, v41
  buffer_load_dword v41, v42, s[20:23], 0 offen
  s_branch L_T5_E
L_T5_1:
  s_cmp_lg_u32 s4, 2
  s_cbranch_scc1 L_T5_2
  s_mov_b32 s58, 2130706432
  buffer_load_dword v41, v40, s[24:27], s58 offen
  s_branch L_T5_E
L_T5_2:
  s_mov_b32 s58, 2130706432
  buffer_load_dword v41, v40, s[24:27], s58 offen
L_T5_E:
  s_waitcnt vmcnt(13)
  s_barrier
  s_waitcnt vmcnt(9)
  s_barrier
  s_add_u32 s73, s70, s86
  s_add_u32 m0, s62, 149504
  s_nop 0
  buffer_load_dwordx4 v33, s[20:23], s73 offen lds
  s_add_u32 m0, s62, 150528
  s_nop 0
  buffer_load_dwordx4 v34, s[20:23], s73 offen lds
  s_add_u32 m0, s62, 151552
  s_nop 0
  buffer_load_dwordx4 v35, s[20:23], s73 offen lds
  s_add_u32 s86, s86, 176128
  s_cmp_eq_u32 s86, 1409024
  s_cselect_b32 s86, 0, s86
  s_add_u32 s73, s70, s86
  s_add_u32 m0, s62, 4096
  s_nop 0
  buffer_load_dwordx4 v33, s[20:23], s73 offen lds
  s_add_u32 m0, s62, 5120
  s_nop 0
  buffer_load_dwordx4 v34, s[20:23], s73 offen lds
  s_add_u32 m0, s62, 6144
  s_nop 0
  buffer_load_dwordx4 v35, s[20:23], s73 offen lds
  s_add_u32 s86, s86, 176128
  s_cmp_eq_u32 s86, 1409024
  s_cselect_b32 s86, 0, s86
  s_waitcnt vmcnt(11)
  s_barrier
  s_add_u32 s73, s70, s86
  s_add_u32 m0, s62, 137216
  s_nop 0
  buffer_load_dwordx4 v33, s[20:23], s73 offen lds
  s_add_u32 m0, s62, 138240
  s_nop 0
  buffer_load_dwordx4 v34, s[20:23], s73 offen lds
  s_add_u32 m0, s62, 139264
  s_nop 0
  buffer_load_dwordx4 v35, s[20:23], s73 offen lds
  s_add_u32 s86, s86, 176128
  s_cmp_eq_u32 s86, 1409024
  s_cselect_b32 s86, 0, s86
  s_waitcnt vmcnt(12)
  s_barrier
  s_waitcnt vmcnt(10)
  s_barrier
  s_barrier
  s_mul_i32 s75, s5, 2048
  s_add_u32 s75, s75, 9961984
  s_and_b32 s59, s6, 16
  s_lshl_b32 s59, s59, 4
  s_add_u32 s75, s75, s59
  s_mov_b32 s58, 0
L_P_POLLB:
  buffer_load_dword v37, v36, s[36:39], s75 offen sc1
  s_waitcnt vmcnt(0)
  v_cmp_ne_u32 vcc, 1, v37
  s_add_u32 s58, s58, 1
  s_cmp_gt_u32 s58, 20000
  s_cbranch_scc1 L_P_POLLB_OK
  s_cbranch_vccnz L_P_POLLB
L_P_POLLB_OK:
  s_add_u32 s73, s71, s87
  s_add_u32 m0, s61, 16384
  s_nop 0
  buffer_load_dwordx4 v5, s[36:39], s73 offen sc1 lds
  s_add_u32 s73, s73, 16384
  s_add_u32 m0, s61, 17408
  s_nop 0
  buffer_load_dwordx4 v5, s[36:39], s73 offen sc1 lds
  s_add_u32 s87, s87, 1024
  s_cmp_eq_u32 s87, 16384
  s_cselect_b32 s87, 0, s87
  s_add_u32 s73, s71, s87
  s_add_u32 m0, s61, 24576
  s_nop 0
  buffer_load_dwordx4 v5, s[36:39], s73 offen sc1 lds
  s_add_u32 s73, s73, 16384
  s_add_u32 m0, s61, 25600
  s_nop 0
  buffer_load_dwordx4 v5, s[36:39], s73 offen sc1 lds
  s_add_u32 s87, s87, 1024
  s_cmp_eq_u32 s87, 16384
  s_cselect_b32 s87, 0, s87
  s_add_u32 s73, s71, s87
  s_add_u32 m0, s61, 32768
  s_nop 0
  buffer_load_dwordx4 v5, s[36:39], s73 offen sc1 lds
  s_add_u32 s73, s73, 16384
  s_add_u32 m0, s61, 33792
  s_nop 0
  buffer_load_dwordx4 v5, s[36:39], s73 offen sc1 lds
  s_add_u32 s87, s87, 1024
  s_cmp_eq_u32 s87, 16384
  s_cselect_b32 s87, 0, s87
  s_add_u32 s73, s71, s87
  s_add_u32 m0, s61, 40960
  s_nop 0
  buffer_load_dwordx4 v5, s[36:39], s73 offen sc1 lds
  s_add_u32 s73, s73, 16384
  s_add_u32 m0, s61, 41984
  s_nop 0
  buffer_load_dwordx4 v5, s[36:39], s73 offen sc1 lds
  s_add_u32 s87, s87, 1024
  s_cmp_eq_u32 s87, 16384
  s_cselect_b32 s87, 0, s87
  s_waitcnt vmcnt(4)
  s_barrier
  s_add_u32 s73, s71, s87
  s_add_u32 m0, s61, 49152
  s_nop 0
  buffer_load_dwordx4 v5, s[36:39], s73 offen sc1 lds
  s_add_u32 s73, s73, 16384
  s_add_u32 m0, s61, 50176
  s_nop 0
  buffer_load_dwordx4 v5, s[36:39], s73 offen sc1 lds
  s_add_u32 s87, s87, 1024
  s_cmp_eq_u32 s87, 16384
  s_cselect_b32 s87, 0, s87
  s_add_u32 s73, s71, s87
  s_add_u32 m0, s61, 57344
  s_nop 0
  buffer_load_dwordx4 v5, s[36:39], s73 offen sc1 lds
  s_add_u32 s73, s73, 16384
  s_add_u32 m0, s61, 58368
  s_nop 0
  buffer_load_dwordx4 v5, s[36:39], s73 offen sc1 lds
  s_add_u32 s87, s87, 1024
  s_cmp_eq_u32 s87, 16384
  s_cselect_b32 s87, 0, s87
  s_add_u32 s73, s71, s87
  s_add_u32 m0, s61, 96256
  s_nop 0
  buffer_load_dwordx4 v5, s[36:39], s73 offen sc1 lds
  s_add_u32 s73, s73, 16384
  s_add_u32 m0, s61, 97280
  s_nop 0
  buffer_load_dwordx4 v5, s[36:39], s73 offen sc1 lds
  s_add_u32 s87, s87, 1024
  s_cmp_eq_u32 s87, 16384
  s_cselect_b32 s87, 0, s87
  s_add_u32 s73, s71, s87
  s_add_u32 m0, s61, 104448
  s_nop 0
  buffer_load_dwordx4 v5, s[36:39], s73 offen sc1 lds
  s_add_u32 s73, s73, 16384
  s_add_u32 m0, s61, 105472
  s_nop 0
  buffer_load_dwordx4 v5, s[36:39], s73 offen sc1 lds
  s_add_u32 s87, s87, 1024
  s_cmp_eq_u32 s87, 16384
  s_cselect_b32 s87, 0, s87
  s_add_u32 s73, s71, s87
  s_add_u32 m0, s61, 112640
  s_nop 0
  buffer_load_dwordx4 v5, s[36:39], s73 offen sc1 lds
  s_add_u32 s73, s73, 16384
  s_add_u32 m0, s61, 113664
  s_nop 0
  buffer_load_dwordx4 v5, s[36:39], s73 offen sc1 lds
  s_add_u32 s87, s87, 1024
  s_cmp_eq_u32 s87, 16384
  s_cselect_b32 s87, 0, s87
  s_add_u32 s73, s71, s87
  s_add_u32 m0, s61, 120832
  s_nop 0
  buffer_load_dwordx4 v5, s[36:39], s73 offen sc1 lds
  s_add_u32 s73, s73, 16384
  s_add_u32 m0, s61, 121856
  s_nop 0
  buffer_load_dwordx4 v5, s[36:39], s73 offen sc1 lds
  s_add_u32 s87, s87, 1024
  s_cmp_eq_u32 s87, 16384
  s_cselect_b32 s87, 0, s87
  s_add_u32 s73, s71, s87
  s_add_u32 m0, s61, 129024
  s_nop 0
  buffer_load_dwordx4 v5, s[36:39], s73 offen sc1 lds
  s_add_u32 s73, s73, 16384
  s_add_u32 m0, s61, 130048
  s_nop 0
  buffer_load_dwordx4 v5, s[36:39], s73 offen sc1 lds
  s_add_u32 s87, s87, 1024
  s_cmp_eq_u32 s87, 16384
  s_cselect_b32 s87, 0, s87
  s_cmp_lg_u32 s4, 0
  s_cbranch_scc1 L_T6_0
  s_mul_i32 s58, s5, 163840
  s_add_u32 s58, s58, 0
  v_add_u32 v42, s58, v40
  v_subrev_u32 v41, 1409024, v42
  v_min_u32 v42, v42, v41
  buffer_load_dword v41, v42, s[24:27], 0 offen
  s_branch L_T6_E
L_T6_0:
  s_cmp_lg_u32 s4, 1
  s_cbranch_scc1 L_T6_1
  s_mul_i32 s58, s5, 163840
  s_add_u32 s58, s58, 262144
  v_add_u32 v42, s58, v40
  v_subrev_u32 v41, 1409024, v42
  v_min_u32 v42, v42, v41
  buffer_load_dword v41, v42, s[24:27], 0 offen
  s_branch L_T6_E
L_T6_1:
  s_cmp_lg_u32 s4, 2
  s_cbranch_scc1 L_T6_2
  s_mov_b32 s58, 2130706432
  buffer_load_dword v41, v40, s[24:27], s58 offen
  s_branch L_T6_E
L_T6_2:
  s_mov_b32 s58, 2130706432
  buffer_load_dword v41, v40, s[24:27], s58 offen
L_T6_E:
  s_waitcnt vmcnt(15)
  s_barrier
  s_add_u32 s73, s71, s87
  s_add_u32 m0, s61, 16384
  s_nop 0
  buffer_load_dwordx4 v5, s[36:39], s73 offen sc1 lds
  s_add_u32 s73, s73, 16384
  s_add_u32 m0, s61, 17408
  s_nop 0
  buffer_load_dwordx4 v5, s[36:39], s73 offen sc1 lds
  s_add_u32 s87, s87, 1024
  s_cmp_eq_u32 s87, 16384
  s_cselect_b32 s87, 0, s87
  s_add_u32 s73, s70, s86
  s_add_u32 m0, s62, 83968
  s_nop 0
  buffer_load_dwordx4 v33, s[20:23], s73 offen lds
  s_add_u32 m0, s62, 84992
  s_nop 0
  buffer_load_dwordx4 v34, s[20:23], s73 offen lds
  s_add_u32 m0, s62, 86016
  s_nop 0
  buffer_load_dwordx4 v35, s[20:23], s73 offen lds
  s_add_u32 s86, s86, 176128
  s_cmp_eq_u32 s86, 1409024
  s_cselect_b32 s86, 0, s86
  s_add_u32 s73, s71, s87
  s_add_u32 m0, s61, 24576
  s_nop 0
  buffer_load_dwordx4 v5, s[36:39], s73 offen sc1 lds
  s_add_u32 s73, s73, 16384
  s_add_u32 m0, s61, 25600
  s_nop 0
  buffer_load_dwordx4 v5, s[36:39], s73 offen sc1 lds
  s_add_u32 s87, s87, 1024
  s_cmp_eq_u32 s87, 16384
  s_cselect_b32 s87, 0, s87
  s_waitcnt vmcnt(18)
  s_barrier
  s_add_u32 s73, s71, s87
  s_add_u32 m0, s61, 32768
  s_nop 0
  buffer_load_dwordx4 v5, s[36:39], s73 offen sc1 lds
  s_add_u32 s73, s73, 16384
  s_add_u32 m0, s61, 33792
  s_nop 0
  buffer_load_dwordx4 v5, s[36:39], s73 offen sc1 lds
  s_add_u32 s87, s87, 1024
  s_cmp_eq_u32 s87, 16384
  s_cselect_b32 s87, 0, s87
  s_add_u32 s73, s70, s86
  s_add_u32 m0, s62, 71680
  s_nop 0
  buffer_load_dwordx4 v33, s[20:23], s73 offen lds
  s_add_u32 m0, s62, 72704
  s_nop 0
  buffer_load_dwordx4 v34, s[20:23], s73 offen lds
  s_add_u32 m0, s62, 73728
  s_nop 0
  buffer_load_dwordx4 v35, s[20:23], s73 offen lds
  s_add_u32 s86, s86, 176128
  s_cmp_eq_u32 s86, 1409024
  s_cselect_b32 s86, 0, s86
  s_add_u32 s73, s71, s87
  s_add_u32 m0, s61, 40960
  s_nop 0
  buffer_load_dwordx4 v5, s[36:39], s73 offen sc1 lds
  s_add_u32 s73, s73, 16384
  s_add_u32 m0, s61, 41984
  s_nop 0
  buffer_load_dwordx4 v5, s[36:39], s73 offen sc1 lds
  s_add_u32 s87, s87, 1024
  s_cmp_eq_u32 s87, 16384
  s_cselect_b32 s87, 0, s87
  s_cmp_lg_u32 s4, 0
  s_cbranch_scc1 L_T7_0
  s_mul_i32 s58, s5, 163840
  s_add_u32 s58, s58, 524288
  v_add_u32 v42, s58, v40
  v_subrev_u32 v41, 1409024, v42
  v_min_u32 v42, v42, v41
  buffer_load_dword v41, v42, s[24:27], 0 offen
  s_branch L_T7_E
L_T7_0:
  s_cmp_lg_u32 s4, 1
  s_cbranch_scc1 L_T7_1
  s_mul_i32 s58, s5, 163840
  s_add_u32 s58, s58, 786432
  v_add_u32 v42, s58, v40
  v_subrev_u32 v41, 1409024, v42
  v_min_u32 v42, v42, v41
  buffer_load_dword v41, v42, s[24:27], 0 offen
  s_branch L_T7_E
L_T7_1:
  s_cmp_lg_u32 s4, 2
  s_cbranch_scc1 L_T7_2
  s_mov_b32 s58, 2130706432
  buffer_load_dword v41, v40, s[24:27], s58 offen
  s_branch L_T7_E
L_T7_2:
  s_mov_b32 s58, 2130706432
  buffer_load_dword v41, v40, s[24:27], s58 offen
L_T7_E:
  s_waitcnt vmcnt(22)
  s_barrier
  s_add_u32 s73, s71, s87
  s_add_u32 m0, s61, 49152
  s_nop 0
  buffer_load_dwordx4 v5, s[36:39], s73 offen sc1 lds
  s_add_u32 s73, s73, 16384
  s_add_u32 m0, s61, 50176
  s_nop 0
  buffer_load_dwordx4 v5, s[36:39], s73 offen sc1 lds
  s_add_u32 s87, s87, 1024
  s_cmp_eq_u32 s87, 16384
  s_cselect_b32 s87, 0, s87
  s_add_u32 s73, s70, s86
  s_add_u32 m0, s62, 149504
  s_nop 0
  buffer_load_dwordx4 v33, s[20:23], s73 offen lds
  s_add_u32 m0, s62, 150528
  s_nop 0
  buffer_load_dwordx4 v34, s[20:23], s73 offen lds
  s_add_u32 m0, s62, 151552
  s_nop 0
  buffer_load_dwordx4 v35, s[20:23], s73 offen lds
  s_add_u32 s86, s86, 176128
  s_cmp_eq_u32 s86, 1409024
  s_cselect_b32 s86, 0, s86
  s_waitcnt vmcnt(23)
  s_barrier
  s_add_u32 s73, s68, s88
  s_add_u32 m0, s60, 108544
  s_nop 0
  buffer_load_dwordx4 v32, s[24:27], s73 offen lds
  s_add_u32 s88, s88, 32768
  s_cmp_eq_u32 s88, 1409024
  s_cselect_b32 s88, 0, s88
  s_add_u32 s73, s68, s88
  s_add_u32 m0, s60, 104448
  s_nop 0
  buffer_load_dwordx4 v32, s[24:27], s73 offen lds
  s_add_u32 s88, s88, 32768
  s_cmp_eq_u32 s88, 1409024
  s_cselect_b32 s88, 0, s88
  s_add_u32 s73, s68, s88
  s_add_u32 m0, s60, 100352
  s_nop 0
  buffer_load_dwordx4 v32, s[24:27], s73 offen lds
  s_add_u32 s88, s88, 32768
  s_cmp_eq_u32 s88, 1409024
  s_cselect_b32 s88, 0, s88
  s_add_u32 s73, s68, s88
  s_add_u32 m0, s60, 96256
  s_nop 0
  buffer_load_dwordx4 v32, s[24:27], s73 offen lds
  s_add_u32 s88, s88, 32768
  s_cmp_eq_u32 s88, 1409024
  s_cselect_b32 s88, 0, s88
  s_add_u32 s73, s68, s88
  s_add_u32 m0, s60, 67584
  s_nop 0
  buffer_load_dwordx4 v32, s[24:27], s73 offen lds
  s_add_u32 s88, s88, 32768
  s_cmp_eq_u32 s88, 1409024
  s_cselect_b32 s88, 0, s88
  s_add_u32 s73, s68, s88
  s_add_u32 m0, s60, 63488
  s_nop 0
  buffer_load_dwordx4 v32, s[24:27], s73 offen lds
  s_add_u32 s88, s88, 32768
  s_cmp_eq_u32 s88, 1409024
  s_cselect_b32 s88, 0, s88
  s_add_u32 s73, s68, s88
  s_add_u32 m0, s60, 59392
  s_nop 0
  buffer_load_dwordx4 v32, s[24:27], s73 offen lds
  s_add_u32 s88, s88, 32768
  s_cmp_eq_u32 s88, 1409024
  s_cselect_b32 s88, 0, s88
  s_add_u32 s73, s68, s88
  s_add_u32 m0, s60, 12288
  s_nop 0
  buffer_load_dwordx4 v32, s[24:27], s73 offen lds
  s_add_u32 s88, s88, 32768
  s_cmp_eq_u32 s88, 1409024
  s_cselect_b32 s88, 0, s88
  s_add_u32 s73, s68, s88
  s_add_u32 m0, s60, 8192
  s_nop 0
  buffer_load_dwordx4 v32, s[24:27], s73 offen lds
  s_add_u32 s88, s88, 32768
  s_cmp_eq_u32 s88, 1409024
  s_cselect_b32 s88, 0, s88
  s_add_u32 s73, s68, s88
  s_add_u32 m0, s60, 4096
  s_nop 0
  buffer_load_dwordx4 v32, s[24:27], s73 offen lds
  s_add_u32 s88, s88, 32768
  s_cmp_eq_u32 s88, 1409024
  s_cselect_b32 s88, 0, s88
  s_add_u32 s73, s68, s88
  s_add_u32 m0, s60, 0
  s_nop 0
  buffer_load_dwordx4 v32, s[24:27], s73 offen lds
  s_add_u32 s88, s88, 32768
  s_cmp_eq_u32 s88, 1409024
  s_cselect_b32 s88, 0, s88
  s_cmp_lg_u32 s4, 0
  s_cbranch_scc1 L_T8_0
  s_cmp_lt_u32 s6, 11
  s_cselect_b32 s59, 0, 262144
  s_cmp_lt_u32 s6, 22
  s_cselect_b32 s59, s59, -442368
  s_mul_i32 s58, s5, 704512
  s_add_u32 s58, s58, s59
  s_add_u32 s58, s58, 4456448
  buffer_load_dword v41, v40, s[36:39], s58 offen sc1
  s_branch L_T8_E
L_T8_0:
  s_cmp_lg_u32 s4, 1
  s_cbranch_scc1 L_T8_1
  s_mul_i32 s58, s5, 163840
  s_add_u32 s58, s58, 1048576
  v_add_u32 v42, s58, v40
  v_subrev_u32 v41, 1409024, v42
  v_min_u32 v42, v42, v41
  buffer_load_dword v41, v42, s[24:27], 0 offen
  s_branch L_T8_E
L_T8_1:
  s_cmp_lg_u32 s4, 2
  s_cbranch_scc1 L_T8_2
  s_mov_b32 s58, 2130706432
  buffer_load_dword v41, v40, s[24:27], s58 offen
  s_branch L_T8_E
L_T8_2:
  s_mov_b32 s58, 2130706432
  buffer_load_dword v41, v40, s[24:27], s58 offen
L_T8_E:
  s_waitcnt vmcnt(27)
  s_barrier
  s_add_u32 s73, s68, s88
  s_add_u32 m0, s60, 145408
  s_nop 0
  buffer_load_dwordx4 v32, s[24:27], s73 offen lds
  s_add_u32 s88, s88, 32768
  s_cmp_eq_u32 s88, 1409024
  s_cselect_b32 s88, 0, s88
  s_add_u32 s73, s68, s88
  s_add_u32 m0, s60, 141312
  s_nop 0
  buffer_load_dwordx4 v32, s[24:27], s73 offen lds
  s_add_u32 s88, s88, 32768
  s_cmp_eq_u32 s88, 1409024
  s_cselect_b32 s88, 0, s88
  s_add_u32 s73, s68, s88
  s_add_u32 m0, s60, 137216
  s_nop 0
  buffer_load_dwordx4 v32, s[24:27], s73 offen lds
  s_add_u32 s88, s88, 32768
  s_cmp_eq_u32 s88, 1409024
  s_cselect_b32 s88, 0, s88
  s_add_u32 s73, s68, s88
  s_add_u32 m0, s60, 124928
  s_nop 0
  buffer_load_dwordx4 v32, s[24:27], s73 offen lds
  s_add_u32 s88, s88, 32768
  s_cmp_eq_u32 s88, 1409024
  s_cselect_b32 s88, 0, s88
  s_add_u32 s73, s68, s88
  s_add_u32 m0, s60, 120832
  s_nop 0
  buffer_load_dwordx4 v32, s[24:27], s73 offen lds
  s_add_u32 s88, s88, 32768
  s_cmp_eq_u32 s88, 1409024
  s_cselect_b32 s88, 0, s88
  s_waitcnt vmcnt(25)
  s_barrier
  s_cmp_lg_u32 s4, 0
  s_cbranch_scc1 L_T9_0
  s_mul_i32 s58, s5, 163840
  s_add_u32 s58, s58, 1310720
  v_add_u32 v42, s58, v40
  v_subrev_u32 v41, 1409024, v42
  v_min_u32 v42, v42, v41
  buffer_load_dword v41, v42, s[24:27], 0 offen
  s_branch L_T9_E
L_T9_0:
  s_cmp_lg_u32 s4, 1
  s_cbranch_scc1 L_T9_1
  s_mov_b32 s58, 2130706432
  buffer_load_dword v41, v40, s[24:27], s58 offen
  s_branch L_T9_E
L_T9_1:
  s_cmp_lg_u32 s4, 2
  s_cbranch_scc1 L_T9_2
  s_mov_b32 s58, 2130706432
  buffer_load_dword v41, v40, s[24:27], s58 offen
  s_branch L_T9_E
L_T9_2:
  s_mov_b32 s58, 2130706432
  buffer_load_dword v41, v40, s[24:27], s58 offen
L_T9_E:
  s_waitcnt vmcnt(18)
  s_barrier
  s_add_u32 s73, s68, s88
  s_add_u32 m0, s60, 133120
  s_nop 0
  buffer_load_dwordx4 v32, s[24:27], s73 offen lds
  s_add_u32 s88, s88, 32768
  s_cmp_eq_u32 s88, 1409024
  s_cselect_b32 s88, 0, s88
  s_add_u32 s73, s68, s88
  s_add_u32 m0, s60, 129024
  s_nop 0
  buffer_load_dwordx4 v32, s[24:27], s73 offen lds
  s_add_u32 s88, s88, 32768
  s_cmp_eq_u32 s88, 1409024
  s_cselect_b32 s88, 0, s88
  s_add_u32 s73, s68, s88
  s_add_u32 m0, s60, 116736
  s_nop 0
  buffer_load_dwordx4 v32, s[24:27], s73 offen lds
  s_add_u32 s88, s88, 32768
  s_cmp_eq_u32 s88, 1409024
  s_cselect_b32 s88, 0, s88
  s_add_u32 s73, s68, s88
  s_add_u32 m0, s60, 112640
  s_nop 0
  buffer_load_dwordx4 v32, s[24:27], s73 offen lds
  s_add_u32 s88, s88, 32768
  s_cmp_eq_u32 s88, 1409024
  s_cselect_b32 s88, 0, s88
  s_add_u32 s73, s68, s88
  s_add_u32 m0, s60, 92160
  s_nop 0
  buffer_load_dwordx4 v32, s[24:27], s73 offen lds
  s_add_u32 s88, s88, 32768
  s_cmp_eq_u32 s88, 1409024
  s_cselect_b32 s88, 0, s88
  s_add_u32 s73, s68, s88
  s_add_u32 m0, s60, 88064
  s_nop 0
  buffer_load_dwordx4 v32, s[24:27], s73 offen lds
  s_add_u32 s88, s88, 32768
  s_cmp_eq_u32 s88, 1409024
  s_cselect_b32 s88, 0, s88
  s_add_u32 s73, s68, s88
  s_add_u32 m0, s60, 83968
  s_nop 0
  buffer_load_dwordx4 v32, s[24:27], s73 offen lds
  s_add_u32 s88, s88, 32768
  s_cmp_eq_u32 s88, 1409024
  s_cselect_b32 s88, 0, s88
  s_add_u32 s73, s68, s88
  s_add_u32 m0, s60, 79872
  s_nop 0
  buffer_load_dwordx4 v32, s[24:27], s73 offen lds
  s_add_u32 s88, s88, 32768
  s_cmp_eq_u32 s88, 1409024
  s_cselect_b32 s88, 0, s88
  s_add_u32 s73, s68, s88
  s_add_u32 m0, s60, 75776
  s_nop 0
  buffer_load_dwordx4 v32, s[24:27], s73 offen lds
  s_add_u32 s88, s88, 32768
  s_cmp_eq_u32 s88, 1409024
  s_cselect_b32 s88, 0, s88
  s_add_u32 s73, s68, s88
  s_add_u32 m0, s60, 71680
  s_nop 0
  buffer_load_dwordx4 v32, s[24:27], s73 offen lds
  s_add_u32 s88, s88, 32768
  s_cmp_eq_u32 s88, 1409024
  s_cselect_b32 s88, 0, s88
  s_add_u32 s73, s68, s88
  s_add_u32 m0, s60, 36864
  s_nop 0
  buffer_load_dwordx4 v32, s[24:27], s73 offen lds
  s_add_u32 s88, s88, 32768
  s_cmp_eq_u32 s88, 1409024
  s_cselect_b32 s88, 0, s88
  s_barrier
  s_mul_i32 s75, s5, 2048
  s_add_u32 s75, s75, 9962496
  s_and_b32 s59, s6, 16
  s_lshl_b32 s59, s59, 4
  s_add_u32 s75, s75, s59
  s_mov_b32 s58, 0
  s_mov_b32 s76, -1
  s_mov_b32 s77, 0xfffffff
  s_mov_b64 exec, s[76:77]
L_P_POLLC:
  buffer_load_dword v37, v36, s[36:39], s75 offen sc1
  s_waitcnt vmcnt(0)
  v_cmp_ne_u32 vcc, 1, v37
  s_add_u32 s58, s58, 1
  s_cmp_gt_u32 s58, 20000
  s_cbranch_scc1 L_P_POLLC_OK
  s_cbranch_vccnz L_P_POLLC
L_P_POLLC_OK:
  s_mov_b64 exec, -1
  s_add_u32 s73, s72, s89
  s_add_u32 m0, s60, 16384
  s_nop 0
  buffer_load_dwordx4 v5, s[36:39], s73 offen sc1 lds
  s_add_u32 s89, s89, 1024
  s_cmp_eq_u32 s89, 44032
  s_cselect_b32 s89, 0, s89
  s_add_u32 s73, s72, s89
  s_add_u32 m0, s60, 20480
  s_nop 0
  buffer_load_dwordx4 v5, s[36:39], s73 offen sc1 lds
  s_add_u32 s89, s89, 1024
  s_cmp_eq_u32 s89, 44032
  s_cselect_b32 s89, 0, s89
  s_add_u32 s73, s72, s89
  s_add_u32 m0, s60, 24576
  s_nop 0
  buffer_load_dwordx4 v5, s[36:39], s73 offen sc1 lds
  s_add_u32 s89, s89, 1024
  s_cmp_eq_u32 s89, 44032
  s_cselect_b32 s89, 0, s89
  s_add_u32 s73, s72, s89
  s_add_u32 m0, s60, 28672
  s_nop 0
  buffer_load_dwordx4 v5, s[36:39], s73 offen sc1 lds
  s_add_u32 s89, s89, 1024
  s_cmp_eq_u32 s89, 44032
  s_cselect_b32 s89, 0, s89
  s_add_u32 s73, s72, s89
  s_add_u32 m0, s60, 32768
  s_nop 0
  buffer_load_dwordx4 v5, s[36:39], s73 offen sc1 lds
  s_add_u32 s89, s89, 1024
  s_cmp_eq_u32 s89, 44032
  s_cselect_b32 s89, 0, s89
  s_add_u32 s73, s72, s89
  s_add_u32 m0, s60, 40960
  s_nop 0
  buffer_load_dwordx4 v5, s[36:39], s73 offen sc1 lds
  s_add_u32 s89, s89, 1024
  s_cmp_eq_u32 s89, 44032
  s_cselect_b32 s89, 0, s89
  s_add_u32 s73, s72, s89
  s_add_u32 m0, s60, 45056
  s_nop 0
  buffer_load_dwordx4 v5, s[36:39], s73 offen sc1 lds
  s_add_u32 s89, s89, 1024
  s_cmp_eq_u32 s89, 44032
  s_cselect_b32 s89, 0, s89
  s_add_u32 s73, s72, s89
  s_add_u32 m0, s60, 49152
  s_nop 0
  buffer_load_dwordx4 v5, s[36:39], s73 offen sc1 lds
  s_add_u32 s89, s89, 1024
  s_cmp_eq_u32 s89, 44032
  s_cselect_b32 s89, 0, s89
  s_waitcnt vmcnt(6)
  s_barrier
  s_add_u32 s73, s72, s89
  s_add_u32 m0, s60, 53248
  s_nop 0
  buffer_load_dwordx4 v5, s[36:39], s73 offen sc1 lds
  s_add_u32 s89, s89, 1024
  s_cmp_eq_u32 s89, 44032
  s_cselect_b32 s89, 0, s89
  s_add_u32 s73, s72, s89
  s_add_u32 m0, s60, 149504
  s_nop 0
  buffer_load_dwordx4 v5, s[36:39], s73 offen sc1 lds
  s_add_u32 s89, s89, 1024
  s_cmp_eq_u32 s89, 44032
  s_cselect_b32 s89, 0, s89
  s_add_u32 s73, s72, s89
  s_add_u32 m0, s60, 153600
  s_nop 0
  buffer_load_dwordx4 v5, s[36:39], s73 offen sc1 lds
  s_add_u32 s89, s89, 1024
  s_cmp_eq_u32 s89, 44032
  s_cselect_b32 s89, 0, s89
  s_add_u32 s73, s72, s89
  s_add_u32 m0, s60, 157696
  s_nop 0
  buffer_load_dwordx4 v5, s[36:39], s73 offen sc1 lds
  s_add_u32 s89, s89, 1024
  s_cmp_eq_u32 s89, 44032
  s_cselect_b32 s89, 0, s89
  s_waitcnt vmcnt(8)
  s_barrier
  s_add_u32 s73, s72, s89
  s_add_u32 m0, s60, 16384
  s_nop 0
  buffer_load_dwordx4 v5, s[36:39], s73 offen sc1 lds
  s_add_u32 s89, s89, 1024
  s_cmp_eq_u32 s89, 44032
  s_cselect_b32 s89, 0, s89
  s_add_u32 s73, s72, s89
  s_add_u32 m0, s60, 20480
  s_nop 0
  buffer_load_dwordx4 v5, s[36:39], s73 offen sc1 lds
  s_add_u32 s89, s89, 1024
  s_cmp_eq_u32 s89, 44032
  s_cselect_b32 s89, 0, s89
  s_add_u32 s73, s72, s89
  s_add_u32 m0, s60, 104448
  s_nop 0
  buffer_load_dwordx4 v5, s[36:39], s73 offen sc1 lds
  s_add_u32 s89, s89, 1024
  s_cmp_eq_u32 s89, 44032
  s_cselect_b32 s89, 0, s89
  s_add_u32 s73, s72, s89
  s_add_u32 m0, s60, 108544
  s_nop 0
  buffer_load_dwordx4 v5, s[36:39], s73 offen sc1 lds
  s_add_u32 s89, s89, 1024
  s_cmp_eq_u32 s89, 44032
  s_cselect_b32 s89, 0, s89
  s_waitcnt vmcnt(8)
  s_barrier
  s_add_u32 s73, s72, s89
  s_add_u32 m0, s60, 24576
  s_nop 0
  buffer_load_dwordx4 v5, s[36:39], s73 offen sc1 lds
  s_add_u32 s89, s89, 1024
  s_cmp_eq_u32 s89, 44032
  s_cselect_b32 s89, 0, s89
  s_add_u32 s73, s72, s89
  s_add_u32 m0, s60, 28672
  s_nop 0
  buffer_load_dwordx4 v5, s[36:39], s73 offen sc1 lds
  s_add_u32 s89, s89, 1024
  s_cmp_eq_u32 s89, 44032
  s_cselect_b32 s89, 0, s89
  s_add_u32 s73, s72, s89
  s_add_u32 m0, s60, 96256
  s_nop 0
  buffer_load_dwordx4 v5, s[36:39], s73 offen sc1 lds
  s_add_u32 s89, s89, 1024
  s_cmp_eq_u32 s89, 44032
  s_cselect_b32 s89, 0, s89
  s_add_u32 s73, s72, s89
  s_add_u32 m0, s60, 100352
  s_nop 0
  buffer_load_dwordx4 v5, s[36:39], s73 offen sc1 lds
  s_add_u32 s89, s89, 1024
  s_cmp_eq_u32 s89, 44032
  s_cselect_b32 s89, 0, s89
  s_waitcnt vmcnt(8)
  s_barrier
  s_add_u32 s73, s72, s89
  s_add_u32 m0, s60, 12288
  s_nop 0
  buffer_load_dwordx4 v5, s[36:39], s73 offen sc1 lds
  s_add_u32 s89, s89, 1024
  s_cmp_eq_u32 s89, 44032
  s_cselect_b32 s89, 0, s89
  s_add_u32 s73, s72, s89
  s_add_u32 m0, s60, 32768
  s_nop 0
  buffer_load_dwordx4 v5, s[36:39], s73 offen sc1 lds
  s_add_u32 s89, s89, 1024
  s_cmp_eq_u32 s89, 44032
  s_cselect_b32 s89, 0, s89
  s_add_u32 s73, s72, s89
  s_add_u32 m0, s60, 40960
  s_nop 0
  buffer_load_dwordx4 v5, s[36:39], s73 offen sc1 lds
  s_add_u32 s89, s89, 1024
  s_cmp_eq_u32 s89, 44032
  s_cselect_b32 s89, 0, s89
  s_add_u32 s73, s72, s89
  s_add_u32 m0, s60, 45056
  s_nop 0
  buffer_load_dwordx4 v5, s[36:39], s73 offen sc1 lds
  s_add_u32 s89, s89, 1024
  s_cmp_eq_u32 s89, 44032
  s_cselect_b32 s89, 0, s89
  s_add_u32 s73, s72, s89
  s_add_u32 m0, s60, 49152
  s_nop 0
  buffer_load_dwordx4 v5, s[36:39], s73 offen sc1 lds
  s_add_u32 s89, s89, 1024
  s_cmp_eq_u32 s89, 44032
  s_cselect_b32 s89, 0, s89
  s_add_u32 s73, s72, s89
  s_add_u32 m0, s60, 57344
  s_nop 0
  buffer_load_dwordx4 v5, s[36:39], s73 offen sc1 lds
  s_add_u32 s89, s89, 1024
  s_cmp_eq_u32 s89, 44032
  s_cselect_b32 s89, 0, s89
  s_add_u32 s73, s72, s89
  s_add_u32 m0, s60, 61440
  s_nop 0
  buffer_load_dwordx4 v5, s[36:39], s73 offen sc1 lds
  s_add_u32 s89, s89, 1024
  s_cmp_eq_u32 s89, 44032
  s_cselect_b32 s89, 0, s89
  s_add_u32 s73, s72, s89
  s_add_u32 m0, s60, 65536
  s_nop 0
  buffer_load_dwordx4 v5, s[36:39], s73 offen sc1 lds
  s_add_u32 s89, s89, 1024
  s_cmp_eq_u32 s89, 44032
  s_cselect_b32 s89, 0, s89
  s_waitcnt vmcnt(10)
  s_barrier
  s_add_u32 s73, s72, s89
  s_add_u32 m0, s60, 0
  s_nop 0
  buffer_load_dwordx4 v5, s[36:39], s73 offen sc1 lds
  s_add_u32 s89, s89, 1024
  s_cmp_eq_u32 s89, 44032
  s_cselect_b32 s89, 0, s89
  s_add_u32 s73, s72, s89
  s_add_u32 m0, s60, 4096
  s_nop 0
  buffer_load_dwordx4 v5, s[36:39], s73 offen sc1 lds
  s_add_u32 s89, s89, 1024
  s_cmp_eq_u32 s89, 44032
  s_cselect_b32 s89, 0, s89
  s_add_u32 s73, s68, s88
  s_add_u32 m0, s60, 157696
  s_nop 0
  buffer_load_dwordx4 v32, s[24:27], s73 offen lds
  s_add_u32 s88, s88, 32768
  s_cmp_eq_u32 s88, 1409024
  s_cselect_b32 s88, 0, s88
  s_add_u32 s73, s68, s88
  s_add_u32 m0, s60, 153600
  s_nop 0
  buffer_load_dwordx4 v32, s[24:27], s73 offen lds
  s_add_u32 s88, s88, 32768
  s_cmp_eq_u32 s88, 1409024
  s_cselect_b32 s88, 0, s88
  s_add_u32 s73, s68, s88
  s_add_u32 m0, s60, 149504
  s_nop 0
  buffer_load_dwordx4 v32, s[24:27], s73 offen lds
  s_add_u32 s88, s88, 32768
  s_cmp_eq_u32 s88, 1409024
  s_cselect_b32 s88, 0, s88
  s_add_u32 s73, s72, s89
  s_add_u32 m0, s60, 8192
  s_nop 0
  buffer_load_dwordx4 v5, s[36:39], s73 offen sc1 lds
  s_add_u32 s89, s89, 1024
  s_cmp_eq_u32 s89, 44032
  s_cselect_b32 s89, 0, s89
  s_add_u32 s73, s72, s89
  s_add_u32 m0, s60, 53248
  s_nop 0
  buffer_load_dwordx4 v5, s[36:39], s73 offen sc1 lds
  s_add_u32 s89, s89, 1024
  s_cmp_eq_u32 s89, 44032
  s_cselect_b32 s89, 0, s89
  s_add_u32 s73, s72, s89
  s_add_u32 m0, s60, 145408
  s_nop 0
  buffer_load_dwordx4 v5, s[36:39], s73 offen sc1 lds
  s_add_u32 s89, s89, 1024
  s_cmp_eq_u32 s89, 44032
  s_cselect_b32 s89, 0, s89
  s_waitcnt vmcnt(12)
  s_barrier
  s_add_u32 s73, s72, s89
  s_add_u32 m0, s60, 16384
  s_nop 0
  buffer_load_dwordx4 v5, s[36:39], s73 offen sc1 lds
  s_add_u32 s89, s89, 1024
  s_cmp_eq_u32 s89, 44032
  s_cselect_b32 s89, 0, s89
  s_add_u32 s73, s72, s89
  s_add_u32 m0, s60, 20480
  s_nop 0
  buffer_load_dwordx4 v5, s[36:39], s73 offen sc1 lds
  s_add_u32 s89, s89, 1024
  s_cmp_eq_u32 s89, 44032
  s_cselect_b32 s89, 0, s89
  s_add_u32 s73, s72, s89
  s_add_u32 m0, s60, 24576
  s_nop 0
  buffer_load_dwordx4 v5, s[36:39], s73 offen sc1 lds
  s_add_u32 s89, s89, 1024
  s_cmp_eq_u32 s89, 44032
  s_cselect_b32 s89, 0, s89
  s_add_u32 s73, s68, s88
  s_add_u32 m0, s60, 141312
  s_nop 0
  buffer_load_dwordx4 v32, s[24:27], s73 offen lds
  s_add_u32 s88, s88, 32768
  s_cmp_eq_u32 s88, 1409024
  s_cselect_b32 s88, 0, s88
  s_add_u32 s73, s68, s88
  s_add_u32 m0, s60, 137216
  s_nop 0
  buffer_load_dwordx4 v32, s[24:27], s73 offen lds
  s_add_u32 s88, s88, 32768
  s_cmp_eq_u32 s88, 1409024
  s_cselect_b32 s88, 0, s88
  s_add_u32 s73, s68, s88
  s_add_u32 m0, s60, 133120
  s_nop 0
  buffer_load_dwordx4 v32, s[24:27], s73 offen lds
  s_add_u32 s88, s88, 32768
  s_cmp_eq_u32 s88, 1409024
  s_cselect_b32 s88, 0, s88
  s_add_u32 s73, s68, s88
  s_add_u32 m0, s60, 129024
  s_nop 0
  buffer_load_dwordx4 v32, s[24:27], s73 offen lds
  s_add_u32 s88, s88, 32768
  s_cmp_eq_u32 s88, 1409024
  s_cselect_b32 s88, 0, s88
  s_add_u32 s73, s68, s88
  s_add_u32 m0, s60, 124928
  s_nop 0
  buffer_load_dwordx4 v32, s[24:27], s73 offen lds
  s_add_u32 s88, s88, 32768
  s_cmp_eq_u32 s88, 1409024
  s_cselect_b32 s88, 0, s88
  s_add_u32 s73, s68, s88
  s_add_u32 m0, s60, 120832
  s_nop 0
  buffer_load_dwordx4 v32, s[24:27], s73 offen lds
  s_add_u32 s88, s88, 32768
  s_cmp_eq_u32 s88, 1409024
  s_cselect_b32 s88, 0, s88
  s_add_u32 s73, s72, s89
  s_add_u32 m0, s60, 28672
  s_nop 0
  buffer_load_dwordx4 v5, s[36:39], s73 offen sc1 lds
  s_add_u32 s89, s89, 1024
  s_cmp_eq_u32 s89, 44032
  s_cselect_b32 s89, 0, s89
  s_add_u32 s73, s72, s89
  s_add_u32 m0, s60, 104448
  s_nop 0
  buffer_load_dwordx4 v5, s[36:39], s73 offen sc1 lds
  s_add_u32 s89, s89, 1024
  s_cmp_eq_u32 s89, 44032
  s_cselect_b32 s89, 0, s89
  s_add_u32 s73, s72, s89
  s_add_u32 m0, s60, 108544
  s_nop 0
  buffer_load_dwordx4 v5, s[36:39], s73 offen sc1 lds
  s_add_u32 s89, s89, 1024
  s_cmp_eq_u32 s89, 44032
  s_cselect_b32 s89, 0, s89
  s_waitcnt vmcnt(15)
  s_barrier
  s_add_u32 s73, s72, s89
  s_add_u32 m0, s60, 12288
  s_nop 0
  buffer_load_dwordx4 v5, s[36:39], s73 offen sc1 lds
  s_add_u32 s89, s89, 1024
  s_cmp_eq_u32 s89, 44032
  s_cselect_b32 s89, 0, s89
  s_add_u32 s73, s72, s89
  s_add_u32 m0, s60, 32768
  s_nop 0
  buffer_load_dwordx4 v5, s[36:39], s73 offen sc1 lds
  s_add_u32 s89, s89, 1024
  s_cmp_eq_u32 s89, 44032
  s_cselect_b32 s89, 0, s89
  s_add_u32 s73, s72, s89
  s_add_u32 m0, s60, 40960
  s_nop 0
  buffer_load_dwordx4 v5, s[36:39], s73 offen sc1 lds
  s_add_u32 s89, s89, 1024
  s_cmp_eq_u32 s89, 44032
  s_cselect_b32 s89, 0, s89
  s_add_u32 s73, s72, s89
  s_add_u32 m0, s60, 45056
  s_nop 0
  buffer_load_dwordx4 v5, s[36:39], s73 offen sc1 lds
  s_add_u32 s89, s89, 1024
  s_cmp_eq_u32 s89, 44032
  s_cselect_b32 s89, 0, s89
  s_add_u32 s73, s68, s88
  s_add_u32 m0, s60, 116736
  s_nop 0
  buffer_load_dwordx4 v32, s[24:27], s73 offen lds
  s_add_u32 s88, s88, 32768
  s_cmp_eq_u32 s88, 1409024
  s_cselect_b32 s88, 0, s88
  s_add_u32 s73, s68, s88
  s_add_u32 m0, s60, 112640
  s_nop 0
  buffer_load_dwordx4 v32, s[24:27], s73 offen lds
  s_add_u32 s88, s88, 32768
  s_cmp_eq_u32 s88, 1409024
  s_cselect_b32 s88, 0, s88
  s_add_u32 s73, s68, s88
  s_add_u32 m0, s60, 100352
  s_nop 0
  buffer_load_dwordx4 v32, s[24:27], s73 offen lds
  s_add_u32 s88, s88, 32768
  s_cmp_eq_u32 s88, 1409024
  s_cselect_b32 s88, 0, s88
  s_add_u32 s73, s68, s88
  s_add_u32 m0, s60, 96256
  s_nop 0
  buffer_load_dwordx4 v32, s[24:27], s73 offen lds
  s_add_u32 s88, s88, 32768
  s_cmp_eq_u32 s88, 1409024
  s_cselect_b32 s88, 0, s88
  s_add_u32 s73, s68, s88
  s_add_u32 m0, s60, 92160
  s_nop 0
  buffer_load_dwordx4 v32, s[24:27], s73 offen lds
  s_add_u32 s88, s88, 32768
  s_cmp_eq_u32 s88, 1409024
  s_cselect_b32 s88, 0, s88
  s_add_u32 s73, s68, s88
  s_add_u32 m0, s60, 88064
  s_nop 0
  buffer_load_dwordx4 v32, s[24:27], s73 offen lds
  s_add_u32 s88, s88, 32768
  s_cmp_eq_u32 s88, 1409024
  s_cselect_b32 s88, 0, s88
  s_add_u32 s73, s68, s88
  s_add_u32 m0, s60, 83968
  s_nop 0
  buffer_load_dwordx4 v32, s[24:27], s73 offen lds
  s_add_u32 s88, s88, 32768
  s_cmp_eq_u32 s88, 1409024
  s_cselect_b32 s88, 0, s88
  s_waitcnt vmcnt(14)
  s_barrier
  s_waitcnt vmcnt(0)
  s_barrier
L_END:
  s_endpgm
L_FIX:
  s_waitcnt vmcnt(0) lgkmcnt(0)
  s_barrier
  s_cmp_lg_u32 s3, 0
  s_cbranch_scc1 L_FIX_W
  s_or_b32 s58, s5, 0x10
  s_lshr_b32 s60, s2, 2
  s_and_b32 s61, s2, 3
  s_bfm_b64 s[62:63], s60, 0
  s_mov_b32 s6, 0
  v_and_b32 v6, 0xf7f7f7f7, v19
  v_bfe_u32 v7, v6, 0, 8
  v_cmp_eq_u32 vcc, s58, v7
  s_nop 0
  s_and_b64 s[64:65], vcc, s[62:63]
  s_bcnt1_i32_b64 s59, s[64:65]
  s_add_u32 s6, s6, s59
  s_lshr_b64 s[64:65], vcc, s60
  s_and_b32 s64, s64, 1
  s_cmp_gt_u32 s61, 0
  s_cselect_b32 s64, s64, 0
  s_add_u32 s6, s6, s64
  v_bfe_u32 v7, v6, 8, 8
  v_cmp_eq_u32 vcc, s58, v7
  s_nop 0
  s_and_b64 s[64:65], vcc, s[62:63]
  s_bcnt1_i32_b64 s59, s[64:65]
  s_add_u32 s6, s6, s59
  s_lshr_b64 s[64:65], vcc, s60
  s_and_b32 s64, s64, 1
  s_cmp_gt_u32 s61, 1
  s_cselect_b32 s64, s64, 0
  s_add_u32 s6, s6, s64
  v_bfe_u32 v7, v6, 16, 8
  v_cmp_eq_u32 vcc, s58, v7
  s_nop 0
  s_and_b64 s[64:65], vcc, s[62:63]
  s_bcnt1_i32_b64 s59, s[64:65]
  s_add_u32 s6, s6, s59
  s_lshr_b64 s[64:65], vcc, s60
  s_and_b32 s64, s64, 1
  s_cmp_gt_u32 s61, 2
  s_cselect_b32 s64, s64, 0
  s_add_u32 s6, s6, s64
  v_bfe_u32 v7, v6, 24, 8
  v_cmp_eq_u32 vcc, s58, v7
  s_nop 0
  s_and_b64 s[64:65], vcc, s[62:63]
  s_bcnt1_i32_b64 s59, s[64:65]
  s_add_u32 s6, s6, s59
  s_lshr_b64 s[64:65], vcc, s60
  s_and_b32 s64, s64, 1
  s_cmp_gt_u32 s61, 3
  s_cselect_b32 s64, s64, 0
  s_add_u32 s6, s6, s64
  s_cmp_ge_u32 s6, 32
  s_cbranch_scc1 L_FIX_GOT
  s_mul_i32 s58, s5, 2048
  s_add_u32 s58, s58, 9961472
  s_lshl_b32 s59, s6, 4
  s_add_u32 s59, s59, s58
  v_mov_b32 v20, 0
  v_mov_b32 v21, 0
  v_mov_b32 v22, 0
  v_mov_b32 v23, 0
  v_lshlrev_b32 v7, 9, v2
  s_mov_b64 exec, 15
  buffer_store_dwordx4 v[20:23], v7, s[36:39], s59 offen
  s_mov_b64 exec, -1
  s_waitcnt vmcnt(0)
  s_or_b32 s58, s5, 24
  v_mov_b32 v6, s58
  v_mov_b32 v7, 0
  s_mov_b64 exec, 1
  buffer_store_byte v6, v7, s[32:35], s2 offen
  s_mov_b64 exec, -1
  s_mov_b32 s97, 0
L_FIX_LOOP:
  v_lshlrev_b32 v7, 2, v2
  buffer_load_dword v19, v7, s[32:35], 0 offen sc1
  s_waitcnt vmcnt(0)
  s_or_b32 s58, s5, 24
  s_mov_b32 s59, 0
  v_and_b32 v6, 0xffffffff, v19
  v_mov_b32 v8, 0
  v_bfe_u32 v7, v6, 0, 8
  v_cmp_eq_u32 vcc, s58, v7
  s_nop 0
  s_bcnt1_i32_b64 s96, vcc
  v_addc_co_u32 v8, vcc, 0, v8, vcc
  s_add_u32 s59, s59, s96
  v_bfe_u32 v7, v6, 8, 8
  v_cmp_eq_u32 vcc, s58, v7
  s_nop 0
  s_bcnt1_i32_b64 s96, vcc
  v_addc_co_u32 v8, vcc, 0, v8, vcc
  s_add_u32 s59, s59, s96
  v_bfe_u32 v7, v6, 16, 8
  v_cmp_eq_u32 vcc, s58, v7
  s_nop 0
  s_bcnt1_i32_b64 s96, vcc
  v_addc_co_u32 v8, vcc, 0, v8, vcc
  s_add_u32 s59, s59, s96
  v_bfe_u32 v7, v6, 24, 8
  v_cmp_eq_u32 vcc, s58, v7
  s_nop 0
  s_bcnt1_i32_b64 s96, vcc
  v_addc_co_u32 v8, vcc, 0, v8, vcc
  s_add_u32 s59, s59, s96
  s_add_u32 s97, s97, 1
  s_cmp_gt_u32 s97, 20000
  s_cbranch_scc1 L_FIX_GOT
  s_cmp_lg_u32 s59, 32
  s_cbranch_scc1 L_FIX_LOOP
L_FIX_GOT:
  v_mov_b32 v6, 0
  v_mov_b32 v7, s6
  v_mov_b32 v8, 162688
  ds_write2_b32 v8, v6, v7 offset0:0 offset1:1
  s_waitcnt lgkmcnt(0)
L_FIX_W:
  s_barrier
  v_mov_b32 v6, 162692
  ds_read_b32 v6, v6
  s_waitcnt lgkmcnt(0)
  v_readfirstlane_b32 s6, v6
  s_mov_b32 s7, 1
  s_cmp_ge_u32 s6, 32
  s_cbranch_scc1 L_END
  s_cmp_ge_u32 s3, 4
  s_cbranch_scc1 L_PROD
  s_branch L_CONS
L_CODE_END:
.section .rodata,"a"
.p2align 6
.amdhsa_kernel sequential_preLN__sliding_local_dilated__dense_activation_relu__prompt_kernel
  .amdhsa_next_free_vgpr 254
  .amdhsa_next_free_sgpr 102
  .amdhsa_accum_offset 256
  .amdhsa_group_segment_fixed_size 0
  .amdhsa_kernarg_size 72
  .amdhsa_user_sgpr_count 2
  .amdhsa_user_sgpr_kernarg_segment_ptr 1
  .amdhsa_system_sgpr_workgroup_id_x 1
.end_amdhsa_kernel
```
